```python
import torch

def _softmax(x, axis=-1):
    return torch.softmax(x, dim=axis)
def _gelu(x):
    return torch.nn.functional.gelu(x, approximate="tanh")
def _silu(x):
    return torch.nn.functional.silu(x)
def _sigmoid(x):
    return torch.sigmoid(x)
def _layernorm(x, axis=-1, eps=1e-5):
    m = x.mean(dim=axis, keepdim=True)
    v = x.var(dim=axis, keepdim=True, unbiased=False)
    return (x - m) / torch.sqrt(v + eps)
def _scatter_add(tgt, idx, src, axis=0):
    return tgt.clone().index_add_(axis, idx, src)
def _segment_sum(src, seg, n):
    out = torch.zeros((n,) + src.shape[1:], dtype=src.dtype)
    return out.index_add_(0, seg, src)
def _pad(x, pw):
    flat = tuple(v for pair in reversed(pw) for v in pair)
    return torch.nn.functional.pad(x, flat)

kernel_name = 'interleave_layers__mha_block_cached__glu_gated_swiglu__decode'

def setup_inputs():

    _w = (lambda a: (lambda t: t.to(torch.bfloat16) if t.is_floating_point() else t)(torch.as_tensor(a)))
    def _A_setup():
        B, Sq, D = 1, 1, 640
        H, Sk, Dh = 32, 4096, 128
        return {
            "x": _w((lambda *s: torch.randn(*s, dtype=torch.bfloat16) * 0.05)(B, Sq, D)),
            "k_cache": _w((lambda *s: torch.randn(*s, dtype=torch.bfloat16) * 0.8)(B, H, Sk, Dh)),
            "v_cache": _w((lambda *s: torch.randn(*s, dtype=torch.bfloat16) * 0.8)(B, H, Sk, Dh)),
            "wq": _w((lambda *s: torch.randn(*s, dtype=torch.bfloat16) * 0.8)(D, H * Dh) * (D ** -0.5)),
            "wo": _w((lambda *s: torch.randn(*s, dtype=torch.bfloat16) * 0.8)(H * Dh, D) * ((H * Dh) ** -0.5)),
        }
    _A_in = _A_setup()

    def _B_setup():
        B, S, D, F = 1, 1, 640, 1728
        return {
            "x": _w((lambda *s: torch.randn(*s, dtype=torch.bfloat16) * 0.05)(B, S, D)),
            "w1": _w((lambda *s: torch.randn(*s, dtype=torch.bfloat16) * 0.2)(D, F) * (2.0 / D) ** 0.5),
            "w3": _w((lambda *s: torch.randn(*s, dtype=torch.bfloat16) * 0.2)(D, F) * (2.0 / D) ** 0.5),
            "w2": _w((lambda *s: torch.randn(*s, dtype=torch.bfloat16) * 0.2)(F, D) * (2.0 / F) ** 0.5),
        }
    _B_in = _B_setup()

    return {
        "A_x": _A_in["x"],
        "A_k_cache": _A_in["k_cache"],
        "A_v_cache": _A_in["v_cache"],
        "A_wq": _A_in["wq"],
        "A_wo": _A_in["wo"],
        "B_x": _B_in["x"],
        "B_w1": _B_in["w1"],
        "B_w3": _B_in["w3"],
        "B_w2": _B_in["w2"],
    }

def reference(A_x, A_k_cache, A_v_cache, A_wq, A_wo, B_x, B_w1, B_w3, B_w2):
    def _A_ref(x, k_cache, v_cache, wq, wo):
        B, Sq, D = x.shape
        H, Dh = 32, 128
        q = (lambda x, *d: x.permute(*d))((x @ wq).reshape(B, Sq, H, Dh), 0, 2, 1, 3)
        scores = torch.einsum("bhqd,bhkd->bhqk", q, k_cache) * (Dh ** -0.5)
        p = _softmax(scores, axis=-1)
        o = torch.einsum("bhqk,bhkd->bhqd", p, v_cache)
        return (lambda x, *d: x.permute(*d))(o, 0, 2, 1, 3).reshape(B, Sq, H * Dh) @ wo

    def _B_ref(x, w1, w3, w2):
        gate = torch.einsum("bsd,df->bsf", x, w1)
        up = torch.einsum("bsd,df->bsf", x, w3)
        h = _silu(gate) * up
        out = torch.einsum("bsf,fd->bsd", h, w2)
        return out

    x = A_x
    x = x + _A_ref(_layernorm(x, axis=-1), A_k_cache, A_v_cache, A_wq, A_wo)
    x = x + _B_ref(_layernorm(x, axis=-1), B_w1, B_w3, B_w2)
    x = x + _A_ref(_layernorm(x, axis=-1), A_k_cache, A_v_cache, A_wq, A_wo)
    x = x + _B_ref(_layernorm(x, axis=-1), B_w1, B_w3, B_w2)
    return x
```

```asm
; @launch grid=(256,1,1) block=(512,1,1) lds=106496
.amdgcn_target "amdgcn-amd-amdhsa--gfx950"
.text
.globl interleave_layers__mha_block_cached__glu_gated_swiglu__decode_kernel
.p2align 8
.type interleave_layers__mha_block_cached__glu_gated_swiglu__decode_kernel,@function
interleave_layers__mha_block_cached__glu_gated_swiglu__decode_kernel:
    s_load_dwordx16 s[4:19], s[0:1], 0
    s_load_dwordx8 s[20:27], s[0:1], 64
    s_cmp_ge_u32 s2, 256
    s_cbranch_scc1 L_end
    v_lshrrev_b32 v12, 6, v0
    v_and_b32 v0, 63, v0
    v_readfirstlane_b32 s28, v12
    s_and_b32 s29, s2, 7
    s_lshr_b32 s30, s2, 3
    s_lshr_b32 s49, s30, 3
    s_and_b32 s50, s30, 16
    s_lshl2_add_u32 s48, s29, s49
    s_xor_b32 s48, s48, s50
    s_lshl_b32 s48, s48, 20
    s_bfe_u32 s49, s30, 0x10000
    s_lshl_b32 s49, s49, 11
    s_or_b32 s48, s48, s49
    s_bfe_u32 s49, s30, 0x10001
    s_lshl_b32 s49, s49, 16
    s_or_b32 s48, s48, s49
    s_bfe_u32 s49, s30, 0x10002
    s_lshl_b32 s49, s49, 19
    s_or_b32 s48, s48, s49
    s_bfe_u32 s49, s28, 0x20000
    s_lshl_b32 s49, s49, 12
    s_or_b32 s48, s48, s49
    s_bfe_u32 s49, s28, 0x10002
    s_lshl_b32 s49, s49, 17
    s_or_b32 s48, s48, s49
    v_lshrrev_b32 v26, 4, v0
    v_and_b32 v27, 7, v0
    v_lshlrev_b32 v27, 8, v27
    v_and_b32 v12, 8, v0
    v_lshl_add_u32 v27, v12, 3, v27
    v_lshl_add_u32 v27, v26, 4, v27
    s_waitcnt lgkmcnt(0)
    s_add_u32 s38, s6, s48
    s_addc_u32 s39, s7, 0
    s_cmp_ge_u32 s28, 4
    s_cbranch_scc1 L_late
    global_load_dwordx4 v[128:131], v27, s[38:39] offset:0 nt
    s_nop 0
    global_load_dwordx4 v[132:135], v27, s[38:39] offset:128 nt
    v_xor_b32 v27, 262144, v27
    global_load_dwordx4 v[136:139], v27, s[38:39] offset:0 nt
    s_nop 0
    global_load_dwordx4 v[140:143], v27, s[38:39] offset:128 nt
    v_xor_b32 v27, 278528, v27
    global_load_dwordx4 v[144:147], v27, s[38:39] offset:0 nt
    s_nop 0
    global_load_dwordx4 v[148:151], v27, s[38:39] offset:128 nt
    v_xor_b32 v27, 262144, v27
    s_waitcnt vmcnt(5)
    s_add_u32 s40, s8, s48
    s_addc_u32 s41, s9, 0
    s_mov_b32 s31, s30
    s_mul_i32 s37, s31, 26
    s_lshr_b32 s37, s37, 8
    s_and_b32 s3, s28, 3
    s_mul_i32 s49, s37, 10
    s_sub_u32 s31, s31, s49
    v_and_b32 v12, 15, v0
    v_and_b32 v28, 1, v26
    v_lshlrev_b32 v28, 18, v28
    v_lshrrev_b32 v29, 5, v0
    v_lshl_add_u32 v28, v29, 14, v28
    v_lshl_add_u32 v28, v12, 4, v28
    v_add_u32 v29, 32768, v28
    s_add_u32 s90, s26, 2048
    s_addc_u32 s91, s27, 0
    s_add_u32 s92, s26, 4096
    s_addc_u32 s93, s27, 0
    s_add_u32 s94, s26, 6144
    s_addc_u32 s95, s27, 0
    s_mul_i32 s49, s29, 163840
    s_add_u32 s14, s26, s49
    s_addc_u32 s15, s27, 0
    v_mov_b64 v[14:15], 0
    v_mov_b64 v[16:17], 0
    v_mov_b64 v[18:19], 0
    v_mov_b64 v[20:21], 0
    v_mov_b64 v[22:23], 0
    v_mov_b64 v[24:25], 0
    s_mov_b32 s47, 16
    s_cmp_eq_u32 s37, 0
    s_cbranch_scc1 L_lw
    s_cmp_eq_u32 s37, 1
    s_cbranch_scc1 L_lf
    s_cmp_lg_u32 s37, 2
    s_cbranch_scc1 L_kv
    s_and_b32 s49, s3, 2
    s_lshl_b32 s49, s49, 11
    s_lshl_b32 s48, s31, 19
    s_lshl_b32 s59, s29, 10
    s_add_u32 s48, s48, s59
    s_lshl_b32 s59, s3, 8
    s_add_u32 s48, s48, s59
    s_xor_b32 s48, s48, s49
    v_lshlrev_b32 v12, 4, v12
    v_and_b32 v13, 16, v0
    v_lshlrev_b32 v13, 1, v13
    v_xor_b32 v12, v12, v13
    v_lshl_add_u32 v12, v26, 13, v12
    v_add_u32 v12, s48, v12
    s_lshl_b32 s52, s3, 14
    s_add_u32 s52, s52, 8192
    s_add_u32 m0, s52, 0
    v_xor_b32 v14, 0, v12
    global_load_lds_dwordx4 v14, s[10:11] nt
    s_add_u32 m0, s52, 1024
    v_xor_b32 v14, 32832, v12
    global_load_lds_dwordx4 v14, s[10:11] nt
    s_add_u32 m0, s52, 2048
    v_xor_b32 v14, 65664, v12
    global_load_lds_dwordx4 v14, s[10:11] nt
    s_add_u32 m0, s52, 3072
    v_xor_b32 v14, 98496, v12
    global_load_lds_dwordx4 v14, s[10:11] nt
    s_add_u32 m0, s52, 4096
    v_xor_b32 v14, 131072, v12
    global_load_lds_dwordx4 v14, s[10:11] nt
    s_add_u32 m0, s52, 5120
    v_xor_b32 v14, 163904, v12
    global_load_lds_dwordx4 v14, s[10:11] nt
    s_add_u32 m0, s52, 6144
    v_xor_b32 v14, 196736, v12
    global_load_lds_dwordx4 v14, s[10:11] nt
    s_add_u32 m0, s52, 7168
    v_xor_b32 v14, 229568, v12
    global_load_lds_dwordx4 v14, s[10:11] nt
    s_add_u32 m0, s52, 8192
    v_xor_b32 v14, 262144, v12
    global_load_lds_dwordx4 v14, s[10:11] nt
    s_add_u32 m0, s52, 9216
    v_xor_b32 v14, 294976, v12
    global_load_lds_dwordx4 v14, s[10:11] nt
    s_add_u32 m0, s52, 10240
    v_xor_b32 v14, 327808, v12
    global_load_lds_dwordx4 v14, s[10:11] nt
    s_add_u32 m0, s52, 11264
    v_xor_b32 v14, 360640, v12
    global_load_lds_dwordx4 v14, s[10:11] nt
    s_add_u32 m0, s52, 12288
    v_xor_b32 v14, 393216, v12
    global_load_lds_dwordx4 v14, s[10:11] nt
    s_add_u32 m0, s52, 13312
    v_xor_b32 v14, 426048, v12
    global_load_lds_dwordx4 v14, s[10:11] nt
    s_add_u32 m0, s52, 14336
    v_xor_b32 v14, 458880, v12
    global_load_lds_dwordx4 v14, s[10:11] nt
    s_add_u32 m0, s52, 15360
    v_xor_b32 v14, 491712, v12
    global_load_lds_dwordx4 v14, s[10:11] nt
    s_branch L_kv
L_lw:
    v_lshrrev_b32 v12, 3, v0
    v_mul_u32_u24 v12, 1280, v12
    v_and_b32 v13, 7, v0
    v_lshlrev_b32 v13, 4, v13
    v_and_b32 v14, 32, v0
    v_xor_b32 v13, v13, v14
    v_add_u32 v12, v12, v13
    s_and_b32 s49, s3, 2
    s_lshl_b32 s49, s49, 3
    s_lshl2_add_u32 s48, s29, s3
    s_xor_b32 s48, s48, s49
    s_mul_i32 s48, s48, 163840
    s_lshl_b32 s59, s31, 7
    s_add_u32 s48, s48, s59
    v_add_u32 v12, s48, v12
    s_lshl_b32 s48, s3, 14
    s_add_u32 s48, s48, 8192
    s_mov_b32 m0, s48
    s_mov_b32 s58, 10240
L_dma_1:
    global_load_lds_dwordx4 v12, s[12:13] nt
    s_add_u32 m0, m0, 1024
    v_xad_u32 v12, v12, 64, s58
    s_sub_u32 s47, s47, 1
    s_cmp_lg_u32 s47, 0
    s_cbranch_scc1 L_dma_1
    s_branch L_kv
L_lf:
L_kv:
    global_load_dwordx4 v[152:155], v27, s[38:39] offset:0 nt
    s_waitcnt vmcnt(5)
    global_load_dwordx4 v[156:159], v27, s[38:39] offset:128 nt
    v_xor_b32 v27, 311296, v27
    s_waitcnt vmcnt(5)
    global_load_dwordx4 v[160:163], v27, s[38:39] offset:0 nt
    s_waitcnt vmcnt(5)
    global_load_dwordx4 v[164:167], v27, s[38:39] offset:128 nt
    v_xor_b32 v27, 262144, v27
    s_waitcnt vmcnt(5)
    global_load_dwordx4 v[168:171], v27, s[38:39] offset:0 nt
    s_waitcnt vmcnt(5)
    s_cmp_ge_u32 s28, 4
    s_cbranch_scc1 L_nob0
    s_cmp_lg_u32 s37, 2
    s_cbranch_scc1 L_nob0
    s_waitcnt vmcnt(5)
    s_barrier
L_nob0:
    global_load_dwordx4 v[172:175], v27, s[38:39] offset:128 nt
    v_xor_b32 v27, 278528, v27
    s_waitcnt vmcnt(5)
    global_load_dwordx4 v[176:179], v27, s[38:39] offset:0 nt
    s_waitcnt vmcnt(5)
    global_load_dwordx4 v[180:183], v27, s[38:39] offset:128 nt
    v_xor_b32 v27, 262144, v27
    s_waitcnt vmcnt(5)
    global_load_dwordx4 v[184:187], v27, s[38:39] offset:0 nt
    s_waitcnt vmcnt(5)
    global_load_dwordx4 v[188:191], v27, s[38:39] offset:128 nt
    s_waitcnt vmcnt(5)
    global_load_dwordx4 v[192:195], v29, s[40:41] offset:0 nt
    s_waitcnt vmcnt(5)
    global_load_dwordx4 v[200:203], v29, s[40:41] offset:256 nt
    s_waitcnt vmcnt(5)
    global_load_dwordx4 v[208:211], v29, s[40:41] offset:512 nt
    s_waitcnt vmcnt(5)
    global_load_dwordx4 v[216:219], v29, s[40:41] offset:768 nt
    s_waitcnt vmcnt(5)
    global_load_dwordx4 v[224:227], v29, s[40:41] offset:1024 nt
    s_waitcnt vmcnt(5)
    global_load_dwordx4 v[232:235], v29, s[40:41] offset:1280 nt
    s_waitcnt vmcnt(5)
    global_load_dwordx4 v[240:243], v29, s[40:41] offset:1536 nt
    s_waitcnt vmcnt(5)
    global_load_dwordx4 v[248:251], v29, s[40:41] offset:1792 nt
    s_waitcnt vmcnt(5)
    global_load_dwordx4 v[96:99], v28, s[40:41] offset:0 nt
    s_waitcnt vmcnt(5)
    global_load_dwordx4 v[100:103], v28, s[40:41] offset:256 nt
    s_waitcnt vmcnt(5)
    global_load_dwordx4 v[104:107], v28, s[40:41] offset:512 nt
    s_waitcnt vmcnt(5)
    global_load_dwordx4 v[108:111], v28, s[40:41] offset:768 nt
    s_waitcnt vmcnt(5)
    global_load_dwordx4 v[112:115], v28, s[40:41] offset:1024 nt
    s_nop 0
    global_load_dwordx4 v[116:119], v28, s[40:41] offset:1280 nt
    s_nop 0
    global_load_dwordx4 v[120:123], v28, s[40:41] offset:1536 nt
    s_nop 0
    global_load_dwordx4 v[124:127], v28, s[40:41] offset:1792 nt
L_kvd:
    s_mov_b32 s38, 0x03ff03ff
    s_mov_b32 s39, s38
    s_cmp_lt_u32 s31, 5
    s_cselect_b32 s41, 0, 4
    s_cselect_b32 s10, 5, 0
    s_add_u32 s10, s10, 115
    s_add_u32 s10, s10, s31
    s_lshr_b32 s11, s28, 2
    s_cbranch_scc1 L_att
    s_cmp_ge_u32 s28, 4
    s_cbranch_scc1 L_perm
    s_barrier
    s_setprio 2
    s_mov_b32 s49, 1323008
    s_load_dword s42, s[26:27], s49
    s_mov_b32 s32, 0
    s_mov_b32 s33, 0x200000
    s_mov_b32 s34, 2
    s_lshr_b32 s35, s30, 3
    s_and_b32 s36, s30, 7
    s_cmp_lt_u32 s29, 6
    s_cselect_b32 s25, 7, 6
    s_mov_b32 s44, 0x05040100
    s_mov_b32 s45, 0x07060302
    s_mov_b32 s6, 0xf000f
    s_mov_b32 s7, s6
    s_mov_b32 s8, 0xff00ff
    s_mov_b32 s9, s8
    v_lshlrev_b32 v11, 2, v0
    v_mov_b32 v30, 0xff
    v_and_b32 v12, 1, v0
    v_mul_u32_u24 v1, 0xaaaa, v12
    v_add_u32 v1, 0x4444, v1
    v_mul_u32_u24 v2, 0x5555, v12
    v_add_u32 v2, 0x8888, v2
    v_lshlrev_b32 v9, 4, v12
    v_lshl_add_u32 v9, v26, 5, v9
    v_mov_b32 v4, 0x3f803f80
    v_mov_b32 v5, 0x3f803f80
    v_mov_b32 v6, 0x3f803f80
    v_mov_b32 v7, 0x3f803f80
    v_lshrrev_b32 v8, 5, v0
    v_lshlrev_b32 v8, 4, v8
    v_and_b32 v12, 1, v26
    v_lshl_add_u32 v8, v12, 2, v8
    v_bfe_u32 v12, v0, 2, 1
    v_add_u32 v8, v8, v12
    v_and_b32 v12, 8, v0
    v_add_u32 v8, v8, v12
    v_mov_b64 v[32:33], 0
    v_mov_b64 v[34:35], 0
    v_mov_b64 v[36:37], 0
    v_mov_b64 v[38:39], 0
    v_mov_b64 v[40:41], 0
    v_mov_b64 v[42:43], 0
    v_mov_b64 v[44:45], 0
    v_mov_b64 v[46:47], 0
    s_waitcnt lgkmcnt(0)
    s_getreg_b32 s49, hwreg(HW_REG_XCC_ID, 0, 3)
    s_and_b32 s24, s42, 0xff
    s_cmp_eq_u32 s24, 0xfe
    s_addc_u32 s43, s42, 1
    s_and_b32 s24, s43, 0xff
    s_and_b32 s42, s43, 0x1fffffff
    s_lshl_b32 s49, s49, 29
    s_or_b32 s42, s42, s49
L_perm:
    s_waitcnt vmcnt(14)
    v_perm_b32 v196, v200, v192, s44
    v_perm_b32 v204, v200, v192, s45
    v_perm_b32 v212, v201, v193, s44
    v_perm_b32 v220, v201, v193, s45
    v_perm_b32 v228, v202, v194, s44
    v_perm_b32 v236, v202, v194, s45
    v_perm_b32 v244, v203, v195, s44
    v_perm_b32 v252, v203, v195, s45
    s_waitcnt vmcnt(12)
    v_perm_b32 v197, v216, v208, s44
    v_perm_b32 v205, v216, v208, s45
    v_perm_b32 v213, v217, v209, s44
    v_perm_b32 v221, v217, v209, s45
    v_perm_b32 v229, v218, v210, s44
    v_perm_b32 v237, v218, v210, s45
    v_perm_b32 v245, v219, v211, s44
    v_perm_b32 v253, v219, v211, s45
    s_waitcnt vmcnt(10)
    v_perm_b32 v198, v232, v224, s44
    v_perm_b32 v206, v232, v224, s45
    v_perm_b32 v214, v233, v225, s44
    v_perm_b32 v222, v233, v225, s45
    v_perm_b32 v230, v234, v226, s44
    v_perm_b32 v238, v234, v226, s45
    v_perm_b32 v246, v235, v227, s44
    v_perm_b32 v254, v235, v227, s45
    s_waitcnt vmcnt(8)
    v_perm_b32 v199, v248, v240, s44
    v_perm_b32 v207, v248, v240, s45
    v_perm_b32 v215, v249, v241, s44
    v_perm_b32 v223, v249, v241, s45
    v_perm_b32 v231, v250, v242, s44
    v_perm_b32 v239, v250, v242, s45
    v_perm_b32 v247, v251, v243, s44
    v_perm_b32 v255, v251, v243, s45
    s_waitcnt vmcnt(6)
    v_perm_b32 v192, v100, v96, s44
    v_perm_b32 v200, v100, v96, s45
    v_perm_b32 v208, v101, v97, s44
    v_perm_b32 v216, v101, v97, s45
    v_perm_b32 v224, v102, v98, s44
    v_perm_b32 v232, v102, v98, s45
    v_perm_b32 v240, v103, v99, s44
    v_perm_b32 v248, v103, v99, s45
    s_waitcnt vmcnt(4)
    v_perm_b32 v193, v108, v104, s44
    v_perm_b32 v201, v108, v104, s45
    v_perm_b32 v209, v109, v105, s44
    v_perm_b32 v217, v109, v105, s45
    v_perm_b32 v225, v110, v106, s44
    v_perm_b32 v233, v110, v106, s45
    v_perm_b32 v241, v111, v107, s44
    v_perm_b32 v249, v111, v107, s45
    s_waitcnt vmcnt(2)
    v_perm_b32 v194, v116, v112, s44
    v_perm_b32 v202, v116, v112, s45
    v_perm_b32 v210, v117, v113, s44
    v_perm_b32 v218, v117, v113, s45
    v_perm_b32 v226, v118, v114, s44
    v_perm_b32 v234, v118, v114, s45
    v_perm_b32 v242, v119, v115, s44
    v_perm_b32 v250, v119, v115, s45
    s_waitcnt vmcnt(0)
    v_perm_b32 v195, v124, v120, s44
    v_perm_b32 v203, v124, v120, s45
    v_perm_b32 v211, v125, v121, s44
    v_perm_b32 v219, v125, v121, s45
    v_perm_b32 v227, v126, v122, s44
    v_perm_b32 v235, v126, v122, s45
    v_perm_b32 v243, v127, v123, s44
    v_perm_b32 v251, v127, v123, s45
    s_cmp_lg_u32 s11, 0
    s_cbranch_scc1 L_pv
    s_cmp_ge_u32 s28, 4
    s_cbranch_scc1 L_att
    s_cmp_eq_u32 s37, 3
    s_cbranch_scc1 L_n0
    s_bitcmp0_b32 2, s37
    s_cbranch_scc1 L_n0r
    s_sleep 70
L_n0r:
    s_cmp_lg_u32 s28, 2
    s_cbranch_scc1 L_noarr
    s_lshl_b32 s48, s29, 9
    s_add_u32 s48, s48, 1310720
    v_and_b32 v16, 31, v0
    v_lshl_add_u32 v16, v16, 4, s48
    v_lshlrev_b32 v17, 4, v0
    v_add_u32 v17, 1318912, v17
    s_cmp_lg_u32 s37, 3
    s_cbranch_scc1 L_bar
    v_mov_b32 v17, v16
L_bar:
    global_load_dword v20, v16, s[26:27] sc1
    global_load_dword v22, v17, s[26:27] sc1
    s_sub_u32 s33, s33, 1
    s_cbranch_scc1 L_exit
    s_waitcnt vmcnt(0)
    v_xor_b32 v20, s42, v20
    v_bitop3_b32 v24, v22, s42, v20 bitop3:0xbe
    v_lshlrev_b32 v24, 3, v24
    v_cmp_ne_u32 vcc, 0, v24
    s_cbranch_vccz L_bard
    s_sleep 40
    s_branch L_bar
L_bard:
    v_cmp_ne_u32 vcc, 0, v20
    v_mov_b32 v21, 1
    v_mov_b32 v15, 0
    s_cmp_lg_u32 vcc_lo, 0
    s_cbranch_scc1 L_spread
L_mode:
    v_lshlrev_b32 v23, 1, v22
    v_cmp_gt_i32 vcc, 0, v22
    v_cmp_gt_i32 s[48:49], 0, v23
    s_and_b32 s50, vcc_lo, 15
    s_mul_i32 s50, s50, 17
    s_bcnt1_i32_b64 s48, s[48:49]
    s_cmp_ge_u32 s48, 32
    s_cselect_b32 s48, 15, 0xf0
    s_xor_b32 s48, s48, s50
    v_lshl_or_b32 v21, s48, 8, v21
    ds_write_b32 v15, v21 offset:0
    s_mul_i32 s48, s30, 896
    v_lshl_add_u32 v27, v0, 7, s48
    s_mov_b64 exec, 0x7f
    global_load_dword v28, v27, s[14:15] sc1 nt
    s_mov_b64 exec, -1
L_noarr:
    s_cmp_ge_u32 s28, 2
    s_cbranch_scc1 L_att
    v_bfe_u32 v18, v0, 4, 1
    v_lshlrev_b32 v18, 6, v18
    v_and_b32 v19, 44, v0
    v_add_u32 v18, v18, v19
    v_and_b32 v19, 2, v0
    v_lshl_add_u32 v18, v19, 3, v18
    v_and_b32 v19, 1, v0
    v_lshl_add_u32 v18, v19, 1, v18
    s_lshl_b32 s48, s28, 7
    v_add_u32 v18, s48, v18
    s_mul_i32 s48, s35, 1536
    s_mul_i32 s59, s28, 768
    s_add_u32 s48, s48, s59
    s_add_u32 s48, s48, 157184
    v_add_u32 v16, s48, v11
L_g0l:
    global_load_dword v60, v16, s[14:15] sc1
    s_sub_u32 s33, s33, 1
    s_cbranch_scc1 L_exit
    s_waitcnt vmcnt(0)
    v_xor_b32 v60, s24, v60
    v_and_b32 v19, 0xff, v60
    v_cmp_ne_u32 vcc, 0, v19
    s_cbranch_vccz L_g0d
    s_sleep 4
    s_branch L_g0l
L_g0d:
    v_mul_f32 v60, 0x3e0293ee, v60
    v_cvt_pk_bf16_f32 v60, v60, v60
    ds_write_b16 v18, v60 offset:512
    s_lshl_b32 s48, s28, 2
    v_mov_b32 v16, s48
    ds_write_b32 v16, v16 offset:4
L_att:
    v_mov_b64 v[52:53], 0
    v_mov_b64 v[54:55], 0
    v_mov_b64 v[56:57], 0
    v_mov_b64 v[58:59], 0
    v_mov_b64 v[60:61], 0
    v_mov_b64 v[64:65], 0
    v_mov_b64 v[68:69], 0
    v_mov_b64 v[72:73], 0
    v_mov_b64 v[76:77], 0
    v_mov_b64 v[80:81], 0
    v_mov_b64 v[84:85], 0
    v_mov_b64 v[88:89], 0
    v_lshrrev_b32 v14, 4, v0
    v_lshlrev_b32 v12, 6, v14
    v_and_b32 v13, 3, v0
    v_lshl_add_u32 v12, v13, 4, v12
    s_lshr_b32 s49, s28, 1
    s_and_b32 s50, s30, 3
    s_lshl_b32 s48, s32, 11
    s_lshl_b32 s59, s49, 9
    s_add_u32 s48, s48, s59
    s_lshl_b32 s59, s50, 7
    s_add_u32 s48, s48, s59
    v_lshl_add_u32 v24, v14, 1, v0
    v_and_b32 v24, 7, v24
    v_and_or_b32 v24, v0, 8, v24
    v_lshl_add_u32 v24, v24, 2, s48
    s_lshl_b32 s48, s32, 13
    s_lshl_b32 s59, s28, 10
    s_add_u32 s48, s48, s59
    s_add_u32 s48, s48, 17408
    v_bfe_u32 v25, v0, 2, 2
    v_lshl_add_u32 v25, v25, 8, v12
    v_add_u32 v25, s48, v25
    s_lshl_b32 s48, s28, 2
    s_lshl_b32 s59, s32, 7
    s_add_u32 s48, s48, s59
    v_lshl_add_u32 v27, v14, 5, s48
    s_lshl_b32 s48, s28, 9
    v_lshl_add_u32 v14, v0, 5, s48
    s_lshl_b32 s48, s28, 2
    s_mul_i32 s59, s32, 96
    s_add_u32 s48, s48, s59
    s_add_u32 s48, s48, 64
    v_mov_b32 v15, s48
    v_mov_b32 v13, 0
    s_lshl_b32 s48, s32, 3
    s_sub_i32 s47, s28, s48
    s_and_b32 s48, s28, 6
    s_cmp_lg_u32 s48, 2
    s_cbranch_scc1 L_nca
    s_mul_i32 s48, s32, 96
    s_add_u32 s48, s48, 64
    v_and_b32 v21, 28, v11
    v_add_u32 v20, s48, v21
    s_lshr_b32 s49, s36, 1
    s_and_b32 s50, s36, 1
    s_lshl_b32 s48, s32, 13
    s_lshl_b32 s59, s35, 11
    s_add_u32 s48, s48, s59
    s_lshl_b32 s59, s49, 8
    s_add_u32 s48, s48, s59
    s_lshl_b32 s59, s50, 5
    s_add_u32 s48, s48, s59
    s_add_u32 s48, s48, 17408
    v_add_u32 v21, s48, v21
    v_bfe_u32 v22, v0, 3, 2
    v_lshl_add_u32 v21, v22, 6, v21
    v_lshrrev_b32 v22, 5, v0
    v_lshl_add_u32 v21, v22, 10, v21
    s_lshl_b32 s48, s32, 11
    s_lshl_b32 s59, s35, 9
    s_add_u32 s48, s48, s59
    s_lshl_b32 s59, s36, 2
    s_add_u32 s48, s48, s59
    v_lshl_add_u32 v22, v22, 5, s48
    v_and_b32 v23, 3, v0
    v_lshl_add_u32 v22, v23, 7, v22
    v_lshlrev_b32 v23, 3, v0
L_nca:
    s_setprio 2
    s_cmp_ge_u32 s28, 4
    s_cbranch_scc1 L_npr
    s_setprio 3
L_npr:
    s_cmp_lt_u32 s47, 4
    s_cbranch_scc1 L_e0
    s_cmp_eq_u32 s32, 0
    s_cbranch_scc1 L_attb
    s_cmp_ge_u32 s28, 2
    s_cbranch_scc1 L_nqs
    v_bfe_u32 v18, v0, 4, 1
    v_lshlrev_b32 v18, 6, v18
    v_and_b32 v19, 44, v0
    v_add_u32 v18, v18, v19
    v_and_b32 v19, 2, v0
    v_lshl_add_u32 v18, v19, 3, v18
    v_and_b32 v19, 1, v0
    v_lshl_add_u32 v18, v19, 1, v18
    s_lshl_b32 s48, s28, 7
    v_add_u32 v18, s48, v18
    s_mul_i32 s48, s35, 5120
    s_mul_i32 s59, s28, 2560
    s_add_u32 s48, s48, s59
    s_add_u32 s48, s48, 69632
    v_add_u32 v16, s48, v11
    s_lshl_b32 s48, s36, 7
    s_add_u32 s48, s48, 5120
    v_and_b32 v17, 124, v11
    v_add_u32 v17, s48, v17
    v_mov_b32 v90, 0
L_nqs:
    s_cmp_lg_u32 s37, 2
    s_cbranch_scc1 L_qgo
    s_cmp_eq_u32 s28, 7
    s_cbranch_scc1 L_attb
    s_mul_i32 s48, s28, 2560
    s_lshl_b32 s59, s31, 8
    s_add_u32 s48, s48, s59
    s_add_u32 s48, s48, 69632
    v_add_u32 v26, s48, v11
    v_mov_b64 v[92:93], 0
    s_mov_b64 exec, s[6:7]
    s_waitcnt lgkmcnt(0)
    s_barrier
    ds_read_b128 v[32:35], v9 offset:256
    s_lshl_b64 exec, exec, 4
    ds_read_b128 v[36:39], v9 offset:256
    s_lshl_b64 exec, exec, 4
    ds_read_b128 v[40:43], v9 offset:256
    s_lshl_b64 exec, exec, 4
    ds_read_b128 v[44:47], v9 offset:256
    s_mov_b64 exec, -1
    s_waitcnt lgkmcnt(3)
    v_smfmac_f32_16x16x64_bf16 v[92:95], v[32:35], v[96:103], v1
    s_waitcnt lgkmcnt(2)
    v_smfmac_f32_16x16x64_bf16 v[92:95], v[36:39], v[104:111], v1
    s_waitcnt lgkmcnt(1)
    v_smfmac_f32_16x16x64_bf16 v[92:95], v[40:43], v[112:119], v1
    s_waitcnt lgkmcnt(0)
    v_smfmac_f32_16x16x64_bf16 v[92:95], v[44:47], v[120:127], v1
    s_cmp_lg_u32 s34, 1
    s_nop 6
    v_add_f32 v92, v92, v93
    s_cbranch_scc1 L_slow_2
    global_store_dword v26, v92, s[14:15]
L_st_3:
L_qgo:
    s_cmp_ge_u32 s28, 2
    s_cbranch_scc1 L_attb
    s_mov_b64 exec, s[38:39]
    global_load_dword v90, v17, s[14:15] sc1
    s_sleep 2
L_pp_7:
    global_load_dword v90, v17, s[14:15] sc1
    s_sub_u32 s33, s33, 1
    s_cbranch_scc1 L_exit
    s_waitcnt vmcnt(1)
    v_cmp_eq_u32 vcc, -1, v90
    s_cbranch_vccnz L_pp_7
    s_mov_b64 exec, -1
    global_load_dword v62, v16, s[14:15] offset:0 sc1
    global_load_dword v63, v16, s[14:15] offset:256 sc1
    global_load_dword v66, v16, s[14:15] offset:512 sc1
    global_load_dword v67, v16, s[14:15] offset:768 sc1
    global_load_dword v70, v16, s[14:15] offset:1024 sc1
    global_load_dword v71, v16, s[14:15] offset:1280 sc1
    global_load_dword v74, v16, s[14:15] offset:1536 sc1
    global_load_dword v75, v16, s[14:15] offset:1792 sc1
    global_load_dword v78, v16, s[14:15] offset:2048 sc1
    global_load_dword v79, v16, s[14:15] offset:2304 sc1
    v_add_f32_dpp v86, v90, v90 row_ror:8 row_mask:0xf bank_mask:0xf
    s_nop 1
    v_add_f32_dpp v86, v86, v86 row_ror:4 row_mask:0xf bank_mask:0xf
    s_nop 1
    v_add_f32_dpp v86, v86, v86 row_ror:2 row_mask:0xf bank_mask:0xf
    s_nop 1
    v_add_f32_dpp v87, v86, v86 row_ror:1 row_mask:0xf bank_mask:0xf
    v_add_f32_dpp v86, v86, v86 row_ror:1 row_mask:0xf bank_mask:0xf
    s_nop 1
    v_permlane16_swap_b32 v86, v87
    v_mul_f32 v86, 0xbacccccd, v86
    v_mul_f32 v87, 0x3acccccd, v87
    v_fma_f32 v87, -v86, v86, v87
    v_max_f32 v87, 0, v87
    v_add_f32 v87, 0x3727c5ac, v87
    v_rsq_f32 v87, v87
    v_mul_f32 v82, v86, v3
    v_mov_b32 v83, 0
    v_mul_f32 v87, 0x3e0293ee, v87
L_gc_5:
    s_waitcnt vmcnt(8)
    v_pk_add_f32 v[48:49], v[62:63], v[82:83]
    s_waitcnt vmcnt(6)
    v_pk_add_f32 v[48:49], v[66:67], v[48:49]
    s_waitcnt vmcnt(4)
    v_pk_add_f32 v[48:49], v[70:71], v[48:49]
    s_waitcnt vmcnt(2)
    v_pk_add_f32 v[48:49], v[74:75], v[48:49]
    s_waitcnt vmcnt(0)
    v_pk_add_f32 v[48:49], v[78:79], v[48:49]
    v_add_f32 v48, v48, v49
    v_mul_f32 v48, v48, v87
    v_cvt_pk_bf16_f32 v48, v48, v48
    ds_write_b16 v18, v48 offset:512
    v_max3_u32 v86, v62, v63, v66
    v_max3_u32 v86, v86, v67, v70
    v_max3_u32 v86, v86, v71, v74
    v_max3_u32 v86, v86, v75, v78
    v_max_u32 v86, v86, v79
    v_cmp_eq_u32 vcc, -1, v86
    s_cbranch_vccnz L_gr_4
L_attb:
    s_mov_b64 exec, s[6:7]
    s_waitcnt vmcnt(16) lgkmcnt(0)
    s_barrier
L_attc:
    ds_read_b128 v[32:35], v12 offset:512
    s_lshl_b64 exec, exec, 4
    ds_read_b128 v[36:39], v12 offset:512
    s_lshl_b64 exec, exec, 4
    ds_read_b128 v[40:43], v12 offset:512
    s_lshl_b64 exec, exec, 4
    ds_read_b128 v[44:47], v12 offset:512
    s_mov_b64 exec, -1
    ds_read_b32 v16, v13 offset:0
    s_waitcnt lgkmcnt(4)
    v_smfmac_f32_16x16x64_bf16 v[52:55], v[32:35], v[128:135], v1
    v_smfmac_f32_16x16x64_bf16 v[56:59], v[32:35], v[136:143], v1
    s_waitcnt lgkmcnt(3)
    v_smfmac_f32_16x16x64_bf16 v[52:55], v[36:39], v[144:151], v1
    v_smfmac_f32_16x16x64_bf16 v[56:59], v[36:39], v[152:159], v1
    s_waitcnt lgkmcnt(2)
    v_smfmac_f32_16x16x64_bf16 v[52:55], v[40:43], v[160:167], v1
    v_smfmac_f32_16x16x64_bf16 v[56:59], v[40:43], v[168:175], v1
    s_waitcnt lgkmcnt(1)
    v_smfmac_f32_16x16x64_bf16 v[52:55], v[44:47], v[176:183], v1
    v_smfmac_f32_16x16x64_bf16 v[56:59], v[44:47], v[184:191], v1
    s_waitcnt lgkmcnt(0)
    v_readfirstlane_b32 s40, v16
    s_nop 0
    s_and_b32 s34, s40, 3
    s_lshr_b32 s40, s40, 8
    s_nop 1
    v_add_f32 v17, v54, v55
    v_add_f32 v16, v58, v59
    s_mov_b64 exec, s[8:9]
    v_add_f32 v17, v56, v57
    v_add_f32 v16, v52, v53
    s_mov_b64 exec, -1
    s_nop 0
    v_add_f32_dpp v16, v17, v16 row_ror:8 row_mask:0xf bank_mask:0xf
    s_nop 1
    v_max_f32_dpp v18, v16, v16 row_ror:8 row_mask:0xf bank_mask:0xf
    s_nop 1
    v_max_f32_dpp v18, v18, v18 row_ror:4 row_mask:0xf bank_mask:0xf
    s_nop 1
    v_max_f32_dpp v18, v18, v18 row_ror:2 row_mask:0xf bank_mask:0xf
    s_nop 1
    v_max_f32_dpp v18, v18, v18 row_ror:1 row_mask:0xf bank_mask:0xf
    s_nop 1
    v_max_f32_dpp v18, v18, v18 row_bcast:15 row_mask:0xa bank_mask:0xf
    s_nop 1
    v_max_f32_dpp v18, v18, v18 row_bcast:31 row_mask:0xc bank_mask:0xf
    s_nop 0
    v_readlane_b32 s46, v18, 63
    s_nop 1
    v_subrev_f32 v16, s46, v16
    v_exp_f32 v16, v16
    v_mov_b32 v18, s46
    ds_write_b32 v15, v18
    v_mov_b32_dpp v17, v16 row_shl:2 row_mask:0xf bank_mask:0xf bound_ctrl:0
    v_cvt_pk_bf16_f32 v48, v16, v17
    s_cmp_lg_u32 s11, 0
    s_nop 0
    v_mov_b32_dpp v49, v48 row_shl:4 row_mask:0xf bank_mask:0xf bound_ctrl:0
    v_mov_b32_dpp v50, v48 row_shl:8 row_mask:0xf bank_mask:0xf bound_ctrl:0
    v_mov_b32_dpp v51, v48 row_shl:12 row_mask:0xf bank_mask:0xf bound_ctrl:0
    s_cbranch_scc1 L_perm
L_pv:
    s_nop 0
    v_smfmac_f32_16x16x64_bf16 v[60:63], v[48:51], v[192:199], v2
    v_add_f32_dpp v19, v16, v16 row_ror:8 row_mask:0xf bank_mask:0xf
    s_nop 0
    v_smfmac_f32_16x16x64_bf16 v[64:67], v[48:51], v[200:207], v2
    v_add_f32_dpp v19, v19, v19 row_ror:4 row_mask:0xf bank_mask:0xf
    s_nop 0
    v_smfmac_f32_16x16x64_bf16 v[68:71], v[48:51], v[208:215], v2
    v_add_f32_dpp v19, v19, v19 row_ror:2 row_mask:0xf bank_mask:0xf
    s_nop 0
    v_smfmac_f32_16x16x64_bf16 v[72:75], v[48:51], v[216:223], v2
    v_add_f32_dpp v19, v19, v19 row_ror:1 row_mask:0xf bank_mask:0xf
    ds_write_b32 v27, v19 offset:1792
    v_smfmac_f32_16x16x64_bf16 v[76:79], v[48:51], v[224:231], v2
    v_add_f32 v52, v60, v61
    v_add_f32 v53, v64, v65
    v_smfmac_f32_16x16x64_bf16 v[80:83], v[48:51], v[232:239], v2
    v_add_f32 v54, v68, v69
    v_smfmac_f32_16x16x64_bf16 v[84:87], v[48:51], v[240:247], v2
    v_add_f32 v55, v72, v73
    v_smfmac_f32_16x16x64_bf16 v[88:91], v[48:51], v[248:255], v2
    s_mov_b64 exec, 0xffff
    ds_write_b128 v14, v[52:55] offset:4096
    v_add_f32 v56, v76, v77
    s_nop 0
    v_add_f32 v57, v80, v81
    s_nop 0
    v_add_f32 v58, v84, v85
    s_nop 0
    v_add_f32 v59, v88, v89
    ds_write_b128 v14, v[56:59] offset:4112
    ds_write_b32 v15, v4 offset:64
    s_mov_b64 exec, -1
    s_setprio 0
    s_cmp_lt_u32 s47, 4
    s_cbranch_scc1 L_e0b
L_e0r:
    s_cmp_eq_u32 s28, 2
    s_cbranch_scc1 L_cstat0
    s_cmp_lg_u32 s28, 3
    s_cbranch_scc1 L_nocomb
    s_setprio 1
L_cm:
    ds_read_b32 v76, v20
    ds_read_b32 v79, v20 offset:64
    ds_read_b64 v[60:61], v23 offset:4096
    ds_read_b64 v[62:63], v23 offset:4608
    ds_read_b64 v[64:65], v23 offset:5120
    ds_read_b64 v[66:67], v23 offset:5632
    s_sub_u32 s33, s33, 1
    s_cbranch_scc1 L_exit
    s_waitcnt lgkmcnt(0)
    v_cmp_eq_u32 s[48:49], -1, v79
    v_cmp_eq_u32 vcc, -1, v76
    s_and_b32 s48, s48, 15
    s_or_b32 s48, s48, vcc_lo
    s_cbranch_scc1 L_cm
    v_max_f32_dpp v78, v76, v76 quad_perm:[1,0,3,2] row_mask:0xf bank_mask:0xf
    s_nop 1
    v_max_f32_dpp v78, v78, v78 quad_perm:[2,3,0,1] row_mask:0xf bank_mask:0xf
    s_nop 1
    v_max_f32_dpp v78, v78, v78 row_half_mirror row_mask:0xf bank_mask:0xf
    v_sub_f32 v76, v76, v78
    v_exp_f32 v76, v76
    s_nop 1
    v_mov_b32_dpp v80, v76 row_newbcast:0 row_mask:0xf bank_mask:0xf
    v_mov_b32_dpp v81, v76 row_newbcast:1 row_mask:0xf bank_mask:0xf
    v_mov_b32_dpp v82, v76 row_newbcast:2 row_mask:0xf bank_mask:0xf
    v_mov_b32_dpp v83, v76 row_newbcast:3 row_mask:0xf bank_mask:0xf
    v_mov_b32_dpp v84, v76 row_newbcast:4 row_mask:0xf bank_mask:0xf
    v_mov_b32_dpp v85, v76 row_newbcast:5 row_mask:0xf bank_mask:0xf
    v_mov_b32_dpp v86, v76 row_newbcast:6 row_mask:0xf bank_mask:0xf
    v_mov_b32_dpp v87, v76 row_newbcast:7 row_mask:0xf bank_mask:0xf
    v_pk_fma_f32 v[60:61], v[60:61], v[80:81], 0 op_sel:[0,0,0] op_sel_hi:[1,0,1]
    v_pk_fma_f32 v[60:61], v[62:63], v[80:81], v[60:61] op_sel:[0,1,0] op_sel_hi:[1,1,1]
    v_pk_fma_f32 v[60:61], v[64:65], v[82:83], v[60:61] op_sel:[0,0,0] op_sel_hi:[1,0,1]
    v_pk_fma_f32 v[60:61], v[66:67], v[82:83], v[60:61] op_sel:[0,1,0] op_sel_hi:[1,1,1]
L_cs:
    ds_read_b32 v79, v20 offset:64
    ds_read_b64 v[68:69], v23 offset:6144
    ds_read_b64 v[70:71], v23 offset:6656
    ds_read_b64 v[72:73], v23 offset:7168
    ds_read_b64 v[74:75], v23 offset:7680
    s_sub_u32 s33, s33, 1
    s_cbranch_scc1 L_exit
    s_cmp_lg_u32 s34, 1
    s_waitcnt lgkmcnt(4)
    v_cmp_eq_u32 vcc, -1, v79
    s_cbranch_vccnz L_cs
    s_waitcnt lgkmcnt(3)
    v_pk_fma_f32 v[60:61], v[68:69], v[84:85], v[60:61] op_sel:[0,0,0] op_sel_hi:[1,0,1]
    s_waitcnt lgkmcnt(2)
    v_pk_fma_f32 v[60:61], v[70:71], v[84:85], v[60:61] op_sel:[0,1,0] op_sel_hi:[1,1,1]
    s_waitcnt lgkmcnt(1)
    v_pk_fma_f32 v[60:61], v[72:73], v[86:87], v[60:61] op_sel:[0,0,0] op_sel_hi:[1,0,1]
    s_waitcnt lgkmcnt(0)
    v_pk_fma_f32 v[60:61], v[74:75], v[86:87], v[60:61] op_sel:[0,1,0] op_sel_hi:[1,1,1]
    global_load_dword v28, v24, s[14:15] sc1
    v_cvt_pk_bf16_f32 v60, v60, v61
    v_min_u32 v64, -2, v60
    s_cbranch_scc1 L_slow_8
    global_store_dword v21, v64, s[14:15]
L_st_9:
    s_cmp_eq_u32 s37, 0
    s_cbranch_scc1 L_w3
L_nocomb:
    s_cmp_eq_u32 s37, 1
    s_cbranch_scc1 L_roleF
    s_cmp_eq_u32 s37, 2
    s_cbranch_scc1 L_roleQ
    s_cmp_lg_u32 s37, 0
    s_cbranch_scc1 L_roleN
    s_cmp_ge_i32 s47, 4
    s_cbranch_scc1 L_w0
L_wos:
L_pp_10:
    global_load_dword v28, v24, s[14:15] sc1
    s_sub_u32 s33, s33, 1
    s_cbranch_scc1 L_exit
    s_waitcnt vmcnt(0)
    v_cmp_eq_u32 vcc, -1, v28
    s_cbranch_vccnz L_pp_10
L_wgo:
    global_load_dwordx4 v[60:63], v25, s[14:15] sc1
L_whr:
    v_max_f32_dpp v82, v28, v28 quad_perm:[1,0,3,2] row_mask:0xf bank_mask:0xf
    s_nop 1
    v_max_f32_dpp v82, v82, v82 quad_perm:[2,3,0,1] row_mask:0xf bank_mask:0xf
    s_nop 1
    v_max_f32_dpp v82, v82, v82 row_half_mirror row_mask:0xf bank_mask:0xf
    v_sub_f32 v80, v28, v82
    v_exp_f32 v80, v80
    s_nop 1
    v_mul_f32_dpp v81, v28, v80 row_ror:8 row_mask:0xf bank_mask:0xf
    s_nop 1
    v_add_f32_dpp v81, v81, v81 quad_perm:[1,0,3,2] row_mask:0xf bank_mask:0xf
    s_nop 1
    v_add_f32_dpp v81, v81, v81 quad_perm:[2,3,0,1] row_mask:0xf bank_mask:0xf
    s_nop 1
    v_add_f32_dpp v81, v81, v81 row_half_mirror row_mask:0xf bank_mask:0xf
    v_rcp_f32 v81, v81
    s_nop 0
    v_mul_f32 v80, v80, v81
    s_nop 1
    v_mov_b32_dpp v82, v80 row_newbcast:0 row_mask:0xf bank_mask:0xf
    v_mov_b32_dpp v83, v80 row_newbcast:1 row_mask:0xf bank_mask:0xf
    v_lshlrev_b32 v18, 4, v0
    s_lshr_b32 s49, s28, 2
    s_lshl_b32 s48, s49, 10
    s_lshl_b32 s59, s3, 2
    s_add_u32 s48, s48, s59
    v_add_u32 v17, s48, v18
    s_sub_u32 s49, s29, s28
    s_and_b32 s49, s49, 7
L_woc:
    v_mov_b64 v[64:65], 0
    v_mov_b64 v[66:67], 0
    v_mov_b64 v[68:69], 0
    v_mov_b64 v[70:71], 0
    v_mov_b64 v[72:73], 0
    v_mov_b64 v[74:75], 0
    v_mov_b64 v[76:77], 0
    v_mov_b64 v[78:79], 0
    s_waitcnt vmcnt(0) lgkmcnt(0)
    v_smfmac_f32_16x16x64_bf16 v[64:67], v[60:63], v[96:103], v1
    v_smfmac_f32_16x16x64_bf16 v[68:71], v[60:63], v[104:111], v1
    v_smfmac_f32_16x16x64_bf16 v[72:75], v[60:63], v[112:119], v1
    v_smfmac_f32_16x16x64_bf16 v[76:79], v[60:63], v[120:127], v1
    v_max3_u32 v80, v60, v61, v62
    v_max_u32 v80, v80, v63
    v_cmp_eq_u32 vcc, -1, v80
    s_cbranch_vccnz L_wor
    s_nop 0
    v_pk_mul_f32 v[64:65], v[64:65], v[82:83] op_sel_hi:[1,0]
    v_pk_mul_f32 v[68:69], v[68:69], v[82:83] op_sel_hi:[1,0]
    v_pk_mul_f32 v[72:73], v[72:73], v[82:83] op_sel_hi:[1,0]
    v_pk_mul_f32 v[76:77], v[76:77], v[82:83] op_sel_hi:[1,0]
    v_pk_fma_f32 v[64:65], v[66:67], v[82:83], v[64:65] op_sel:[0,1,0]
    v_pk_fma_f32 v[68:69], v[70:71], v[82:83], v[68:69] op_sel:[0,1,0]
    v_pk_fma_f32 v[72:73], v[74:75], v[82:83], v[72:73] op_sel:[0,1,0]
    v_pk_fma_f32 v[76:77], v[78:79], v[82:83], v[76:77] op_sel:[0,1,0]
    v_add_f32 v64, v64, v65
    v_add_f32 v72, v72, v73
    v_add_f32 v68, v68, v69
    v_add_f32 v76, v76, v77
    v_permlane32_swap_b32 v64, v72
    v_add_f32 v64, v64, v72
    v_permlane32_swap_b32 v68, v76
    v_add_f32 v68, v68, v76
    v_lshl_add_u32 v16, s49, 8, v11
    s_nop 0
    v_permlane16_swap_b32 v64, v68
    v_add_f32 v64, v64, v68
    ds_write_b32 v17, v64 offset:2048
    s_lshr_b32 s58, s40, s28
    s_and_b32 s58, s58, 1
    s_and_b32 s48, s28, 3
    s_mul_i32 s48, s48, 163840
    s_lshl_b32 s59, s58, 13
    s_add_u32 s48, s48, s59
    s_mul_i32 s59, s32, 1310720
    s_add_u32 s48, s48, s59
    s_lshl_b32 s59, s31, 14
    s_add_u32 s48, s48, s59
    s_add_u32 s48, s48, 2097152
    s_cmp_eq_u32 s49, 0
    s_waitcnt lgkmcnt(0)
    s_barrier
    ds_read_b128 v[84:87], v18 offset:2048
    ds_read_b128 v[88:91], v18 offset:3072
    s_cbranch_scc1 L_wown
    v_add_u32 v19, s48, v16
    s_cmp_eq_u32 s32, 0
    s_waitcnt lgkmcnt(1)
    v_pk_add_f32 v[84:85], v[84:85], v[86:87]
    s_waitcnt lgkmcnt(0)
    v_pk_add_f32 v[88:89], v[88:89], v[90:91]
    v_pk_add_f32 v[84:85], v[84:85], v[88:89]
    v_add_f32 v84, v84, v85
    v_bfi_b32 v84, v30, s43, v84
    s_cbranch_scc1 L_wc0
    global_store_dword v19, v84, s[26:27] sc1
    global_store_dword v19, v84, s[90:91] sc1
    global_store_dword v19, v84, s[92:93] sc1
L_wc0:
    global_store_dword v19, v84, s[94:95] sc1
    s_cmp_lg_u32 s32, 0
    s_cbranch_scc1 L_exit
    s_sleep 20
    v_mov_b32 v17, 0
    v_add_u32 v19, 655360, v19
    s_mov_b32 exec_lo, 0x10001
    s_mov_b32 exec_hi, 0x10001
    global_atomic_add v19, v17, s[26:27]
    global_atomic_add v19, v17, s[90:91]
    global_atomic_add v19, v17, s[92:93]
    global_atomic_add v19, v17, s[94:95]
    s_mov_b64 exec, -1
    s_sleep 16
    v_add_u32 v19, 655360, v19
    s_mov_b32 exec_lo, 0x10001
    s_mov_b32 exec_hi, 0x10001
    global_atomic_add v19, v17, s[26:27]
    global_atomic_add v19, v17, s[90:91]
    global_atomic_add v19, v17, s[92:93]
    global_atomic_add v19, v17, s[94:95]
    s_mov_b64 exec, -1
    s_cmp_lg_u32 s28, s41
    s_cbranch_scc1 L_next
    s_lshr_b32 s58, s40, s41
    s_and_b32 s58, s58, 1
    s_lshl_b32 s48, s10, 14
    s_lshl_b32 s59, s58, 13
    s_add_u32 s48, s48, s59
    s_add_u32 s48, s48, 2097152
    v_add_u32 v19, s48, v16
    s_mov_b32 exec_lo, 0x10001
    s_mov_b32 exec_hi, 0x10001
    global_atomic_add v19, v17, s[26:27]
    global_atomic_add v19, v17, s[90:91]
    global_atomic_add v19, v17, s[92:93]
    global_atomic_add v19, v17, s[94:95]
    s_mov_b64 exec, -1
    s_branch L_next
L_wown:
    s_mul_i32 s48, s32, 5120
    s_lshl_b32 s59, s31, 8
    s_add_u32 s48, s48, s59
    s_add_u32 s48, s48, 7168
    v_add_u32 v19, s48, v11
    s_cmp_lg_u32 s34, 1
    s_waitcnt lgkmcnt(1)
    v_pk_add_f32 v[84:85], v[84:85], v[86:87]
    s_waitcnt lgkmcnt(0)
    v_pk_add_f32 v[88:89], v[88:89], v[90:91]
    v_pk_add_f32 v[84:85], v[84:85], v[88:89]
    v_add_f32 v84, v84, v85
    v_bfi_b32 v84, v30, s43, v84
    s_cbranch_scc1 L_slow_11
    global_store_dword v19, v84, s[14:15]
L_st_12:
    s_cmp_lg_u32 s32, 0
    s_cbranch_scc1 L_exit
    s_sleep 1
    s_mul_i32 s48, s31, 6912
    s_add_u32 s48, s48, 28672
    v_lshl_add_u32 v27, v0, 7, s48
    s_mov_b32 exec_lo, 0xffffffff
    s_mov_b32 exec_hi, 0x3fffff
    global_load_dword v29, v27, s[14:15] sc1 nt
    s_mov_b64 exec, -1
L_nt_13:
    s_waitcnt vmcnt(0)
    s_branch L_next
L_roleF:
    s_cmp_lg_u32 s32, 0
    s_cbranch_scc1 L_fnd
    s_mov_b32 s47, 8
    s_lshr_b32 s54, s28, 2
    s_lshl_b32 s54, s54, 3
    s_and_b32 s49, s3, 1
    s_cmp_lt_u32 s3, 2
    s_cselect_b64 s[50:51], s[16:17], s[18:19]
    s_mul_i32 s48, s3, 14336
    s_mul_i32 s59, s54, 896
    s_add_u32 s48, s48, s59
    s_add_u32 s48, s48, 8192
    s_mov_b32 m0, s48
    v_cmp_lt_u32 vcc, 27, v0
    v_mov_b32 v13, 3008
    s_nop 0
    v_cndmask_b32 v12, 0, v13, vcc
    v_lshl_add_u32 v12, v0, 4, v12
    s_mul_i32 s53, s29, 7
    s_min_u32 s53, s53, 48
    s_mul_i32 s48, s31, 221184
    s_lshl_b32 s59, s53, 6
    s_add_u32 s48, s48, s59
    s_mul_i32 s59, s49, 110592
    s_add_u32 s48, s48, s59
    s_mul_i32 s59, s54, 6912
    s_add_u32 s48, s48, s59
    v_add_u32 v12, s48, v12
    s_barrier
    s_cmp_lt_u32 s29, 6
    s_cselect_b32 exec_lo, -1, 0xf0ffffff
    s_mov_b32 exec_hi, 0xfffff
    s_cselect_b32 exec_hi, 0xffffff, exec_hi
    s_mov_b32 s58, 6912
L_dma_14:
    global_load_lds_dwordx4 v12, s[50:51]
    s_add_u32 m0, m0, 896
    v_xad_u32 v12, v12, 0, s58
    s_sub_u32 s47, s47, 1
    s_cmp_lg_u32 s47, 0
    s_cbranch_scc1 L_dma_14
    s_mov_b64 exec, -1
    s_waitcnt vmcnt(0)
    s_barrier
L_fnd:
    s_cmp_eq_u32 s28, 7
    s_cbranch_scc1 L_fred
    s_cmp_ge_u32 s28, s25
    s_cbranch_scc1 L_fidle
    s_mul_i32 s52, s28, 2560
    s_lshl_b32 s59, s31, 8
    s_add_u32 s52, s52, s59
    s_cmp_eq_u32 s32, 0
    s_cbranch_scc1 L_f0
L_f1:
    s_mul_i32 s48, s32, 17920
    s_add_u32 s48, s48, s52
    s_add_u32 s48, s48, 33792
    v_add_u32 v14, s48, v11
    v_mov_b64 v[92:93], 0
    s_mov_b64 exec, s[6:7]
    s_barrier
    ds_read_b128 v[32:35], v9 offset:256
    s_lshl_b64 exec, exec, 4
    ds_read_b128 v[36:39], v9 offset:256
    s_lshl_b64 exec, exec, 4
    ds_read_b128 v[40:43], v9 offset:256
    s_lshl_b64 exec, exec, 4
    ds_read_b128 v[44:47], v9 offset:256
    s_mov_b64 exec, -1
    s_waitcnt lgkmcnt(3)
    v_smfmac_f32_16x16x64_bf16 v[92:95], v[32:35], v[96:103], v1
    s_waitcnt lgkmcnt(2)
    v_smfmac_f32_16x16x64_bf16 v[92:95], v[36:39], v[104:111], v1
    s_waitcnt lgkmcnt(1)
    v_smfmac_f32_16x16x64_bf16 v[92:95], v[40:43], v[112:119], v1
    s_waitcnt lgkmcnt(0)
    v_smfmac_f32_16x16x64_bf16 v[92:95], v[44:47], v[120:127], v1
    s_cmp_lg_u32 s34, 1
    s_nop 6
    v_add_f32 v92, v92, v93
    s_cbranch_scc1 L_slow_15
    global_store_dword v14, v92, s[14:15]
L_st_16:
    s_branch L_next
L_fred:
    s_lshr_b32 s58, s40, s29
    s_and_b32 s58, s58, 1
    s_and_b32 s48, s29, 3
    s_mul_i32 s48, s48, 163840
    s_lshl_b32 s59, s58, 13
    s_add_u32 s48, s48, s59
    s_mul_i32 s59, s32, 1310720
    s_add_u32 s48, s48, s59
    s_lshl_b32 s59, s31, 14
    s_add_u32 s48, s48, s59
    s_add_u32 s48, s48, 2097152
    v_add_u32 v20, s48, v11
    s_mul_i32 s48, s32, 5120
    s_lshl_b32 s59, s31, 8
    s_add_u32 s48, s48, s59
    s_add_u32 s48, s48, 90112
    v_add_u32 v24, s48, v11
    v_add_u32 v21, -82944, v24
    s_lshl_b32 s48, s32, 11
    s_lshl_b32 s59, s31, 2
    s_add_u32 s48, s48, s59
    s_add_u32 s48, s48, 4096
    v_lshrrev_b32 v25, 5, v0
    v_lshl_add_u32 v25, v25, 6, s48
    v_and_b32 v22, 7, v0
    v_lshl_add_u32 v25, v22, 7, v25
    v_lshlrev_b32 v22, 1, v0
    v_mov_b32 v69, 0
    s_sub_u32 s56, 0, s24
    s_subb_u32 s57, 0, s24
    s_mov_b32 s47, 0
    s_cmp_lg_u32 s32, 0
    s_cbranch_scc1 L_r0_19
    s_lshl_b32 s48, s31, 7
    v_add_u32 v60, s48, v22
    v_mov_b32 v68, 0
    global_load_short_d16_hi v68, v60, s[4:5]
    s_mov_b32 s47, 8
    s_branch L_fb_18
    s_branch L_res_17
L_r0_19:
L_pp_20:
    global_load_dword v68, v24, s[14:15] offset:-2560 sc1
    s_sub_u32 s33, s33, 1
    s_cbranch_scc1 L_exit
    s_waitcnt vmcnt(0)
    v_cmp_eq_u32 vcc, -1, v68
    s_cbranch_vccnz L_pp_20
L_res_17:
    global_load_dword v48, v21, s[14:15] sc1
    s_nop 9
    global_load_dword v48, v21, s[14:15] sc1
    s_nop 9
    global_load_dword v48, v21, s[14:15] sc1
    s_nop 9
L_pp_21:
    global_load_dword v48, v21, s[14:15] sc1
    s_sub_u32 s33, s33, 1
    s_cbranch_scc1 L_exit
    s_waitcnt vmcnt(3)
    v_bitop3_b32 v76, v48, s24, v30 bitop3:0x28
    v_cmp_ne_u32 vcc, 0, v76
    s_cbranch_vccnz L_pp_21
    s_sleep 1
    global_load_dword v48, v21, s[14:15] sc1
    global_load_dword v49, v20, s[26:27] offset:256 sc1
    global_load_dword v50, v20, s[26:27] offset:512 sc1
    global_load_dword v51, v20, s[26:27] offset:768 sc1
    global_load_dword v52, v20, s[26:27] offset:1024 sc1
    global_load_dword v53, v20, s[26:27] offset:1280 sc1
    global_load_dword v54, v20, s[26:27] offset:1536 sc1
    global_load_dword v55, v20, s[26:27] offset:1792 sc1
    s_sleep 3
    global_load_dword v48, v21, s[14:15] sc1
    global_load_dword v49, v20, s[90:91] offset:256 sc1
    global_load_dword v50, v20, s[90:91] offset:512 sc1
    global_load_dword v51, v20, s[90:91] offset:768 sc1
    global_load_dword v52, v20, s[90:91] offset:1024 sc1
    global_load_dword v53, v20, s[90:91] offset:1280 sc1
    global_load_dword v54, v20, s[90:91] offset:1536 sc1
    global_load_dword v55, v20, s[90:91] offset:1792 sc1
    s_sleep 3
    global_load_dword v48, v21, s[14:15] sc1
    global_load_dword v49, v20, s[92:93] offset:256 sc1
    global_load_dword v50, v20, s[92:93] offset:512 sc1
    global_load_dword v51, v20, s[92:93] offset:768 sc1
    global_load_dword v52, v20, s[92:93] offset:1024 sc1
    global_load_dword v53, v20, s[92:93] offset:1280 sc1
    global_load_dword v54, v20, s[92:93] offset:1536 sc1
    global_load_dword v55, v20, s[92:93] offset:1792 sc1
    s_waitcnt vmcnt(16)
L_try_22:
    v_lshl_add_u64 v[60:61], v[48:49], 0, s[56:57]
    v_pk_add_f32 v[70:71], v[60:61], v[68:69]
    v_lshl_add_u64 v[62:63], v[50:51], 0, s[56:57]
    v_lshl_add_u64 v[64:65], v[52:53], 0, s[56:57]
    v_pk_add_f32 v[72:73], v[62:63], v[64:65]
    v_lshl_add_u64 v[66:67], v[54:55], 0, s[56:57]
    v_pk_add_f32 v[70:71], v[70:71], v[66:67]
    v_pk_add_f32 v[70:71], v[70:71], v[72:73]
    v_add_f32 v70, v70, v71
    v_cvt_pk_bf16_f32 v71, v70, v70
    ds_write_b16 v22, v71 offset:256
    v_and_b32 v74, 0xffff0000, v71
    v_mul_f32 v77, v74, v74
    v_mov_b32 v76, v74
    v_or3_b32 v75, v60, v61, v62
    v_or3_b32 v75, v75, v63, v64
    v_or3_b32 v75, v75, v65, v66
    v_bitop3_b32 v75, v75, v67, v30 bitop3:0xa8
    v_cmp_ne_u32 vcc, 0, v75
    v_permlane32_swap_b32 v76, v77
    v_add_f32 v76, v76, v77
    s_cbranch_vccnz L_rm_23
    s_waitcnt lgkmcnt(0)
    s_barrier
    v_add_f32_dpp v76, v76, v76 row_ror:8 row_mask:0xf bank_mask:0xf
    s_nop 1
    v_add_f32_dpp v76, v76, v76 row_ror:4 row_mask:0xf bank_mask:0xf
    s_nop 1
    v_add_f32_dpp v76, v76, v76 row_ror:2 row_mask:0xf bank_mask:0xf
    s_nop 1
    v_add_f32_dpp v76, v76, v76 row_ror:1 row_mask:0xf bank_mask:0xf
    s_nop 1
    v_add_f32_dpp v76, v76, v76 row_bcast:15 row_mask:0xa bank_mask:0xf
    s_cmp_lg_u32 s34, 1
    s_mov_b32 exec_lo, 0xff0000
    s_mov_b32 exec_hi, 0xff0000
    s_cbranch_scc1 L_slow_25
    global_store_dword v25, v76, s[14:15]
L_st_26:
    s_mov_b64 exec, -1
    s_cbranch_scc1 L_slow_27
    global_store_dword v24, v74, s[14:15]
L_st_28:
    s_waitcnt vmcnt(2)
    s_branch L_next
L_roleQ:
    s_cmp_eq_u32 s32, 0
    s_cbranch_scc1 L_q0
L_rq1:
    s_cmp_eq_u32 s28, 7
    s_cbranch_scc1 L_q7
    s_cmp_ge_u32 s28, 4
    s_cbranch_scc1 L_now2
    v_lshlrev_b32 v22, 7, v8
    v_bfe_u32 v13, v8, 2, 2
    v_xor_b32 v13, s3, v13
    v_lshl_add_u32 v22, v13, 5, v22
    v_and_b32 v13, 3, v0
    v_lshl_add_u32 v22, v13, 3, v22
    v_add_u32 v22, 73728, v22
    s_cmp_eq_u32 s32, 0
    s_cbranch_scc1 L_nw2f
    ds_read_b64_tr_b16 v[96:97], v22 offset:0
    ds_read_b64_tr_b16 v[98:99], v22 offset:256
    ds_read_b64_tr_b16 v[100:101], v22 offset:4096
    ds_read_b64_tr_b16 v[102:103], v22 offset:4352
    ds_read_b64_tr_b16 v[104:105], v22 offset:8192
    ds_read_b64_tr_b16 v[106:107], v22 offset:8448
    ds_read_b64_tr_b16 v[108:109], v22 offset:12288
    ds_read_b64_tr_b16 v[110:111], v22 offset:12544
    ds_read_b64_tr_b16 v[112:113], v22 offset:16384
    ds_read_b64_tr_b16 v[114:115], v22 offset:16640
    ds_read_b64_tr_b16 v[116:117], v22 offset:20480
    ds_read_b64_tr_b16 v[118:119], v22 offset:20736
    ds_read_b64_tr_b16 v[120:121], v22 offset:24576
    ds_read_b64_tr_b16 v[122:123], v22 offset:24832
    ds_read_b64_tr_b16 v[124:125], v22 offset:28672
    ds_read_b64_tr_b16 v[126:127], v22 offset:28928
L_nw2f:
    v_mov_b64 v[92:93], 0
    v_and_b32 v15, 60, v11
    s_lshl_b32 s48, s31, 14
    s_lshl_b32 s59, s3, 6
    s_add_u32 s48, s48, s59
    s_add_u32 s48, s48, 2752512
    v_add_u32 v17, s48, v15
    v_lshrrev_b32 v16, 4, v0
    v_sub_u32 v20, 7, v16
    v_sub_u32 v21, s29, v20
    v_and_b32 v21, 7, v21
    v_lshl_add_u32 v20, v20, 8, v17
    v_bfe_u32 v23, s40, v21, 1
    v_lshl_add_u32 v20, v23, 13, v20
    v_and_b32 v21, 3, v21
    v_mul_u32_u24 v21, 163840, v21
    v_add_u32 v18, v20, v21
    v_sub_u32 v20, 3, v16
    v_sub_u32 v21, s29, v20
    v_and_b32 v21, 7, v21
    v_lshl_add_u32 v20, v20, 8, v17
    v_bfe_u32 v23, s40, v21, 1
    v_lshl_add_u32 v20, v23, 13, v20
    v_and_b32 v21, 3, v21
    v_mul_u32_u24 v21, 163840, v21
    v_add_u32 v19, v20, v21
    s_lshr_b32 s58, s40, s41
    s_and_b32 s58, s58, 1
    s_lshl_b32 s48, s10, 14
    s_lshl_b32 s59, s58, 13
    s_add_u32 s48, s48, s59
    s_add_u32 s48, s48, 2097152
    s_sub_u32 s49, s29, s41
    s_and_b32 s49, s49, 7
    s_add_u32 s48, s48, 0
    s_lshl_b32 s59, s49, 8
    s_add_u32 s48, s48, s59
    s_lshl_b32 s59, s3, 6
    s_add_u32 s48, s48, s59
    v_add_u32 v17, s48, v15
    s_mul_i32 s48, s32, 5120
    s_lshl_b32 s59, s31, 8
    s_add_u32 s48, s48, s59
    s_lshl_b32 s59, s3, 6
    s_add_u32 s48, s48, s59
    s_add_u32 s48, s48, 9728
    v_add_u32 v15, s48, v15
L_now2:
    s_cmp_ge_u32 s28, s25
    s_cbranch_scc1 L_hb
    s_mul_i32 s48, s32, 17920
    s_mul_i32 s59, s28, 2560
    s_add_u32 s48, s48, s59
    s_add_u32 s48, s48, 33792
    v_add_u32 v12, s48, v11
    s_lshl_b32 s48, s32, 11
    s_lshl_b32 s59, s36, 7
    s_add_u32 s48, s48, s59
    s_add_u32 s48, s48, 4096
    v_and_b32 v13, 124, v11
    v_add_u32 v13, s48, v13
    v_mov_b32 v90, 0
    v_lshrrev_b32 v14, 5, v0
    v_mul_u32_u24 v14, 448, v14
    v_lshl_add_u32 v14, v0, 1, v14
    s_lshl_b32 s48, s28, 6
    v_add_u32 v14, s48, v14
    s_cmp_eq_u32 s32, 0
    s_cbranch_scc1 L_w2f
L_w2r:
    s_mov_b64 exec, s[38:39]
    global_load_dword v90, v13, s[14:15] sc1
    s_sleep 2
L_pp_32:
    global_load_dword v90, v13, s[14:15] sc1
    s_sub_u32 s33, s33, 1
    s_cbranch_scc1 L_exit
    s_waitcnt vmcnt(1)
    v_cmp_eq_u32 vcc, -1, v90
    s_cbranch_vccnz L_pp_32
    s_mov_b64 exec, -1
L_hgo:
    global_load_dword v62, v12, s[14:15] offset:0 sc1
    global_load_dword v63, v12, s[14:15] offset:256 sc1
    global_load_dword v66, v12, s[14:15] offset:512 sc1
    global_load_dword v67, v12, s[14:15] offset:768 sc1
    global_load_dword v70, v12, s[14:15] offset:1024 sc1
    global_load_dword v71, v12, s[14:15] offset:1280 sc1
    global_load_dword v74, v12, s[14:15] offset:1536 sc1
    global_load_dword v75, v12, s[14:15] offset:1792 sc1
    global_load_dword v78, v12, s[14:15] offset:2048 sc1
    global_load_dword v79, v12, s[14:15] offset:2304 sc1
    v_add_f32_dpp v86, v90, v90 row_ror:8 row_mask:0xf bank_mask:0xf
    s_nop 1
    v_add_f32_dpp v86, v86, v86 row_ror:4 row_mask:0xf bank_mask:0xf
    s_nop 1
    v_add_f32_dpp v86, v86, v86 row_ror:2 row_mask:0xf bank_mask:0xf
    s_nop 1
    v_add_f32_dpp v87, v86, v86 row_ror:1 row_mask:0xf bank_mask:0xf
    v_add_f32_dpp v86, v86, v86 row_ror:1 row_mask:0xf bank_mask:0xf
    s_nop 1
    v_permlane16_swap_b32 v86, v87
    v_mul_f32 v86, 0xbacccccd, v86
    v_mul_f32 v87, 0x3acccccd, v87
    v_fma_f32 v87, -v86, v86, v87
    v_max_f32 v87, 0, v87
    v_add_f32 v87, 0x3727c5ac, v87
    v_rsq_f32 v87, v87
    v_mul_f32 v82, v86, v10
    v_mov_b32 v83, 0
L_gc_30:
    s_waitcnt vmcnt(8)
    v_pk_add_f32 v[48:49], v[62:63], v[82:83]
    s_waitcnt vmcnt(6)
    v_pk_add_f32 v[48:49], v[66:67], v[48:49]
    s_waitcnt vmcnt(4)
    v_pk_add_f32 v[48:49], v[70:71], v[48:49]
    s_waitcnt vmcnt(2)
    v_pk_add_f32 v[48:49], v[74:75], v[48:49]
    s_waitcnt vmcnt(0)
    v_pk_add_f32 v[48:49], v[78:79], v[48:49]
    v_add_f32 v48, v48, v49
    v_mul_f32 v48, v48, v87
    v_mov_b32 v49, v48
    v_mul_f32 v50, 0xbfb8aa3b, v48
    v_exp_f32 v50, v50
    v_permlane32_swap_b32 v48, v49
    v_add_f32 v50, 1.0, v50
    v_rcp_f32 v50, v50
    v_mul_f32 v48, v48, v49
    v_mul_f32 v48, v48, v50
    v_cvt_pk_bf16_f32 v48, v48, v48
    ds_write_b16 v14, v48 offset:768
    v_max3_u32 v86, v62, v63, v66
    v_max3_u32 v86, v86, v67, v70
    v_max3_u32 v86, v86, v71, v74
    v_max3_u32 v86, v86, v75, v78
    v_max_u32 v86, v86, v79
    v_cmp_eq_u32 vcc, -1, v86
    s_cbranch_vccnz L_gr_29
L_hb:
    s_cmp_ge_u32 s28, 4
    s_waitcnt lgkmcnt(0)
    s_barrier
    s_cbranch_scc1 L_nopush
    ds_read_b128 v[60:63], v9 offset:768
    ds_read_b128 v[64:67], v9 offset:896
    ds_read_b128 v[68:71], v9 offset:1024
    ds_read_b128 v[72:75], v9 offset:1152
    s_waitcnt lgkmcnt(3)
    v_smfmac_f32_16x16x64_bf16 v[92:95], v[60:63], v[96:103], v1
    s_waitcnt lgkmcnt(2)
    v_smfmac_f32_16x16x64_bf16 v[92:95], v[64:67], v[104:111], v1
    s_waitcnt lgkmcnt(1)
    v_smfmac_f32_16x16x64_bf16 v[92:95], v[68:71], v[112:119], v1
    s_waitcnt lgkmcnt(0)
    v_smfmac_f32_16x16x64_bf16 v[92:95], v[72:75], v[120:127], v1
    s_cmp_lg_u32 s32, 0
    s_cbranch_scc1 L_push1
    s_cmp_lg_u32 s34, 1
    s_nop 4
    v_add_f32 v92, v92, v93
    v_bfi_b32 v94, v30, s43, v92
    global_store_dword v18, v94, s[26:27] sc1
    s_mov_b32 exec_hi, 0xffff
    global_store_dword v19, v94, s[26:27] sc1
    s_mov_b64 exec, 0xffff
    s_cbranch_scc1 L_slow_33
    global_store_dword v15, v94, s[14:15]
L_st_34:
    s_mov_b64 exec, -1
    global_store_dword v18, v94, s[90:91] sc1
    s_mov_b32 exec_hi, 0xffff
    global_store_dword v19, v94, s[90:91] sc1
    s_mov_b64 exec, -1
    global_store_dword v18, v94, s[92:93] sc1
    s_mov_b32 exec_hi, 0xffff
    global_store_dword v19, v94, s[92:93] sc1
    s_mov_b64 exec, -1
    global_store_dword v18, v94, s[94:95] sc1
    s_mov_b32 exec_hi, 0xffff
    global_store_dword v19, v94, s[94:95] sc1
    s_mov_b64 exec, -1
L_nopush:
    s_cmp_lg_u32 s32, 0
    s_cbranch_scc1 L_exit
    v_lshrrev_b32 v13, 1, v8
    v_and_b32 v13, 6, v13
    v_and_or_b32 v13, v8, 1, v13
    v_lshlrev_b32 v13, 5, v13
    s_and_b32 s48, s28, 1
    s_lshr_b32 s49, s28, 1
    s_lshl_b32 s48, s48, 7
    s_lshl_b32 s59, s49, 14
    s_add_u32 s48, s48, s59
    v_xor_b32 v13, s48, v13
    v_lshl_add_u32 v12, v8, 8, v13
    v_and_b32 v13, 3, v0
    v_lshl_add_u32 v12, v13, 3, v12
    ds_read_b64_tr_b16 v[96:97], v12 offset:8192
    ds_read_b64_tr_b16 v[98:99], v12 offset:8704
    ds_read_b64_tr_b16 v[100:101], v12 offset:16384
    ds_read_b64_tr_b16 v[102:103], v12 offset:16896
    v_xor_b32 v13, 32, v12
    ds_read_b64_tr_b16 v[104:105], v13 offset:8192
    ds_read_b64_tr_b16 v[106:107], v13 offset:8704
    ds_read_b64_tr_b16 v[108:109], v13 offset:16384
    ds_read_b64_tr_b16 v[110:111], v13 offset:16896
    v_xor_b32 v13, 64, v12
    ds_read_b64_tr_b16 v[112:113], v13 offset:8192
    ds_read_b64_tr_b16 v[114:115], v13 offset:8704
    ds_read_b64_tr_b16 v[116:117], v13 offset:16384
    ds_read_b64_tr_b16 v[118:119], v13 offset:16896
    v_xor_b32 v13, 96, v12
    ds_read_b64_tr_b16 v[120:121], v13 offset:8192
    ds_read_b64_tr_b16 v[122:123], v13 offset:8704
    ds_read_b64_tr_b16 v[124:125], v13 offset:16384
    ds_read_b64_tr_b16 v[126:127], v13 offset:16896
L_next:
    s_cmp_lg_u32 s32, 0
    s_cbranch_scc1 L_exit
    s_mov_b32 s32, 1
    s_mov_b32 s11, 0
    s_branch L_att
L_q7:
    s_cmp_lg_u32 s32, 0
    s_cbranch_scc1 L_last
    v_lshrrev_b32 v13, 1, v8
    v_and_b32 v13, 6, v13
    v_and_or_b32 v13, v8, 1, v13
    v_lshlrev_b32 v13, 5, v13
    s_and_b32 s48, s28, 1
    s_lshr_b32 s49, s28, 1
    s_lshl_b32 s48, s48, 7
    s_lshl_b32 s59, s49, 14
    s_add_u32 s48, s48, s59
    v_xor_b32 v13, s48, v13
    v_lshl_add_u32 v12, v8, 8, v13
    v_and_b32 v13, 3, v0
    v_lshl_add_u32 v12, v13, 3, v12
    ds_read_b64_tr_b16 v[96:97], v12 offset:8192
    ds_read_b64_tr_b16 v[98:99], v12 offset:8704
    ds_read_b64_tr_b16 v[100:101], v12 offset:16384
    ds_read_b64_tr_b16 v[102:103], v12 offset:16896
    v_xor_b32 v13, 32, v12
    ds_read_b64_tr_b16 v[104:105], v13 offset:8192
    ds_read_b64_tr_b16 v[106:107], v13 offset:8704
    ds_read_b64_tr_b16 v[108:109], v13 offset:16384
    ds_read_b64_tr_b16 v[110:111], v13 offset:16896
    v_xor_b32 v13, 64, v12
    ds_read_b64_tr_b16 v[112:113], v13 offset:8192
    ds_read_b64_tr_b16 v[114:115], v13 offset:8704
    ds_read_b64_tr_b16 v[116:117], v13 offset:16384
    ds_read_b64_tr_b16 v[118:119], v13 offset:16896
    v_xor_b32 v13, 96, v12
    ds_read_b64_tr_b16 v[120:121], v13 offset:8192
    ds_read_b64_tr_b16 v[122:123], v13 offset:8704
    ds_read_b64_tr_b16 v[124:125], v13 offset:16384
    ds_read_b64_tr_b16 v[126:127], v13 offset:16896
    s_lshl_b32 s48, s31, 8
    s_add_u32 s48, s48, 87552
    v_add_u32 v14, s48, v11
    v_mov_b64 v[92:93], 0
L_qred:
    s_lshr_b32 s58, s40, s29
    s_and_b32 s58, s58, 1
    s_and_b32 s48, s29, 3
    s_mul_i32 s48, s48, 163840
    s_lshl_b32 s59, s58, 13
    s_add_u32 s48, s48, s59
    s_mul_i32 s59, s32, 1310720
    s_add_u32 s48, s48, s59
    s_lshl_b32 s59, s31, 14
    s_add_u32 s48, s48, s59
    s_add_u32 s48, s48, 2752512
    s_lshr_b32 s58, s40, s41
    s_and_b32 s58, s58, 1
    s_lshl_b32 s49, s10, 14
    s_lshl_b32 s59, s58, 13
    s_add_u32 s49, s49, s59
    s_add_u32 s49, s49, 2097152
    s_cmp_lg_u32 s32, 0
    s_cselect_b32 s48, s49, s48
    v_add_u32 v20, s48, v11
    s_mul_i32 s48, s32, 5120
    s_lshl_b32 s59, s31, 8
    s_add_u32 s48, s48, s59
    s_add_u32 s48, s48, 92672
    v_add_u32 v24, s48, v11
    v_add_u32 v21, -82944, v24
    s_lshl_b32 s48, s32, 11
    s_lshl_b32 s59, s31, 2
    s_add_u32 s48, s48, s59
    s_add_u32 s48, s48, 5120
    v_lshrrev_b32 v25, 5, v0
    v_lshl_add_u32 v25, v25, 6, s48
    v_and_b32 v22, 7, v0
    v_lshl_add_u32 v25, v22, 7, v25
    v_lshlrev_b32 v22, 1, v0
    v_mov_b32 v69, 0
    s_sub_u32 s56, 0, s24
    s_subb_u32 s57, 0, s24
    s_mov_b32 s47, 0
    s_cmp_lg_u32 s32, 0
    s_cbranch_scc1 L_r1_37
    s_barrier
L_r1_37:
L_pp_38:
    global_load_dword v68, v24, s[14:15] offset:-2560 sc1
    s_sub_u32 s33, s33, 1
    s_cbranch_scc1 L_exit
    s_waitcnt vmcnt(0)
    v_cmp_eq_u32 vcc, -1, v68
    s_cbranch_vccnz L_pp_38
L_res_35:
    s_barrier
    s_sleep 12
    global_load_dword v48, v21, s[14:15] sc1
    global_load_dword v49, v20, s[26:27] offset:256 sc1
    global_load_dword v50, v20, s[26:27] offset:512 sc1
    global_load_dword v51, v20, s[26:27] offset:768 sc1
    global_load_dword v52, v20, s[26:27] offset:1024 sc1
    global_load_dword v53, v20, s[26:27] offset:1280 sc1
    global_load_dword v54, v20, s[26:27] offset:1536 sc1
    global_load_dword v55, v20, s[26:27] offset:1792 sc1
    s_sleep 3
    global_load_dword v48, v21, s[14:15] sc1
    global_load_dword v49, v20, s[90:91] offset:256 sc1
    global_load_dword v50, v20, s[90:91] offset:512 sc1
    global_load_dword v51, v20, s[90:91] offset:768 sc1
    global_load_dword v52, v20, s[90:91] offset:1024 sc1
    global_load_dword v53, v20, s[90:91] offset:1280 sc1
    global_load_dword v54, v20, s[90:91] offset:1536 sc1
    global_load_dword v55, v20, s[90:91] offset:1792 sc1
    s_sleep 3
    global_load_dword v48, v21, s[14:15] sc1
    global_load_dword v49, v20, s[92:93] offset:256 sc1
    global_load_dword v50, v20, s[92:93] offset:512 sc1
    global_load_dword v51, v20, s[92:93] offset:768 sc1
    global_load_dword v52, v20, s[92:93] offset:1024 sc1
    global_load_dword v53, v20, s[92:93] offset:1280 sc1
    global_load_dword v54, v20, s[92:93] offset:1536 sc1
    global_load_dword v55, v20, s[92:93] offset:1792 sc1
    s_cmp_lg_u32 s32, 0
    s_waitcnt vmcnt(16)
L_try_39:
    v_lshl_add_u64 v[60:61], v[48:49], 0, s[56:57]
    v_pk_add_f32 v[70:71], v[60:61], v[68:69]
    v_lshl_add_u64 v[62:63], v[50:51], 0, s[56:57]
    v_lshl_add_u64 v[64:65], v[52:53], 0, s[56:57]
    v_pk_add_f32 v[72:73], v[62:63], v[64:65]
    v_lshl_add_u64 v[66:67], v[54:55], 0, s[56:57]
    v_pk_add_f32 v[70:71], v[70:71], v[66:67]
    v_pk_add_f32 v[70:71], v[70:71], v[72:73]
    v_add_f32 v70, v70, v71
    v_cvt_pk_bf16_f32 v71, v70, v70
    s_cbranch_scc1 L_final
    ds_write_b16 v22, v71 offset:256
    v_and_b32 v74, 0xffff0000, v71
    v_mul_f32 v77, v74, v74
    v_mov_b32 v76, v74
    v_or3_b32 v75, v60, v61, v62
    v_or3_b32 v75, v75, v63, v64
    v_or3_b32 v75, v75, v65, v66
    v_bitop3_b32 v75, v75, v67, v30 bitop3:0xa8
    v_cmp_ne_u32 vcc, 0, v75
    v_permlane32_swap_b32 v76, v77
    v_add_f32 v76, v76, v77
    s_cbranch_vccnz L_rm_40
    s_mov_b64 exec, s[6:7]
    s_waitcnt lgkmcnt(0)
    s_barrier
    ds_read_b128 v[32:35], v9 offset:256
    s_lshl_b64 exec, exec, 4
    ds_read_b128 v[36:39], v9 offset:256
    s_lshl_b64 exec, exec, 4
    ds_read_b128 v[40:43], v9 offset:256
    s_lshl_b64 exec, exec, 4
    ds_read_b128 v[44:47], v9 offset:256
    s_mov_b64 exec, -1
    v_add_f32_dpp v76, v76, v76 row_ror:8 row_mask:0xf bank_mask:0xf
    s_nop 1
    v_add_f32_dpp v76, v76, v76 row_ror:4 row_mask:0xf bank_mask:0xf
    s_nop 1
    v_add_f32_dpp v76, v76, v76 row_ror:2 row_mask:0xf bank_mask:0xf
    s_nop 1
    v_add_f32_dpp v76, v76, v76 row_ror:1 row_mask:0xf bank_mask:0xf
    s_nop 1
    v_add_f32_dpp v76, v76, v76 row_bcast:15 row_mask:0xa bank_mask:0xf
    s_cmp_lg_u32 s34, 1
    s_mov_b32 exec_lo, 0xff0000
    s_mov_b32 exec_hi, 0xff0000
    s_cbranch_scc1 L_slow_42
    global_store_dword v25, v76, s[14:15]
L_st_43:
    s_mov_b64 exec, -1
    s_waitcnt lgkmcnt(3)
    v_smfmac_f32_16x16x64_bf16 v[92:95], v[32:35], v[96:103], v1
    s_waitcnt lgkmcnt(2)
    v_smfmac_f32_16x16x64_bf16 v[92:95], v[36:39], v[104:111], v1
    s_waitcnt lgkmcnt(1)
    v_smfmac_f32_16x16x64_bf16 v[92:95], v[40:43], v[112:119], v1
    s_waitcnt lgkmcnt(0)
    v_smfmac_f32_16x16x64_bf16 v[92:95], v[44:47], v[120:127], v1
    s_nop 7
    v_add_f32 v92, v92, v93
    s_cbranch_scc1 L_slow_44
    global_store_dword v14, v92, s[14:15]
L_st_45:
    s_cbranch_scc1 L_slow_46
    global_store_dword v24, v74, s[14:15]
L_st_47:
    s_waitcnt vmcnt(3)
    s_branch L_next
L_push1:
    s_mov_b64 exec, 0xffff
    s_cmp_eq_u32 s29, s41
    s_cbranch_scc1 L_push0
    s_nop 2
    v_add_f32 v92, v92, v93
    v_bfi_b32 v92, v30, s43, v92
    global_store_dword v17, v92, s[26:27] sc1
    global_store_dword v17, v92, s[90:91] sc1
    global_store_dword v17, v92, s[92:93] sc1
    global_store_dword v17, v92, s[94:95] sc1
    s_branch L_exit
L_push0:
    s_cmp_lg_u32 s34, 1
    s_nop 1
    v_add_f32 v92, v92, v93
    v_bfi_b32 v92, v30, s43, v92
    s_cbranch_scc1 L_slow_48
    global_store_dword v15, v92, s[14:15]
L_st_49:
    s_branch L_exit
L_last:
    s_cmp_lg_u32 s29, s41
    s_cbranch_scc1 L_exit
    s_lshl_b32 s48, s31, 7
    v_lshl_add_u32 v14, v0, 1, s48
    s_cmp_lg_u32 s31, 0
    s_cbranch_scc1 L_qred
    v_mov_b32 v12, 1323008
    v_mov_b32 v13, s43
    s_mov_b64 exec, 0x1
    global_store_dword v12, v13, s[26:27]
    s_mov_b64 exec, -1
    s_branch L_qred
L_final:
    v_or3_b32 v75, v60, v61, v62
    v_or3_b32 v75, v75, v63, v64
    v_or3_b32 v75, v75, v65, v66
    v_bitop3_b32 v75, v75, v67, v30 bitop3:0xa8
    v_cmp_ne_u32 vcc, 0, v75
    s_cbranch_vccnz L_rm_40
    global_store_short v14, v71, s[22:23]
    s_branch L_exit
L_late:
    s_setprio 3
    s_add_u32 s40, s8, s48
    s_addc_u32 s41, s9, 0
    s_mov_b32 s31, s30
    s_mul_i32 s37, s31, 26
    s_lshr_b32 s37, s37, 8
    s_and_b32 s3, s28, 3
    s_mul_i32 s49, s37, 10
    s_sub_u32 s31, s31, s49
    v_and_b32 v12, 15, v0
    v_and_b32 v28, 1, v26
    v_lshlrev_b32 v28, 18, v28
    v_lshrrev_b32 v29, 5, v0
    v_lshl_add_u32 v28, v29, 14, v28
    v_lshl_add_u32 v28, v12, 4, v28
    v_add_u32 v29, 32768, v28
    s_add_u32 s90, s26, 2048
    s_addc_u32 s91, s27, 0
    s_add_u32 s92, s26, 4096
    s_addc_u32 s93, s27, 0
    s_add_u32 s94, s26, 6144
    s_addc_u32 s95, s27, 0
    s_mul_i32 s49, s29, 163840
    s_add_u32 s14, s26, s49
    s_addc_u32 s15, s27, 0
    v_mov_b64 v[14:15], 0
    v_mov_b64 v[16:17], 0
    v_mov_b64 v[18:19], 0
    v_mov_b64 v[20:21], 0
    v_mov_b64 v[22:23], 0
    v_mov_b64 v[24:25], 0
    v_lshlrev_b32 v11, 2, v0
    s_mov_b32 s49, 1323008
    s_load_dword s42, s[26:27], s49
    s_cmp_lg_u32 s37, 2
    s_cbranch_scc1 L_nox
    v_lshlrev_b32 v12, 4, v0
    global_load_dwordx4 v[68:71], v12, s[4:5]
    global_load_dword v72, v11, s[4:5] offset:1024
    s_lshl_b32 s48, s31, 7
    v_and_b32 v12, 16, v12
    v_lshl_add_u32 v12, v26, 5, v12
    v_add_u32 v12, s48, v12
    global_load_dwordx4 v[64:67], v12, s[4:5]
L_nox:
    v_mov_b32 v52, -1
    v_mov_b32 v13, 0
    ds_write_b32 v11, v52
    ds_write_b32 v11, v52 offset:1792
    ds_write_b32 v11, v13 offset:1024
    s_cmp_lg_u32 s28, 7
    s_cbranch_scc1 L_noclr
    v_mov_b32 v53, -1
    v_mov_b32 v54, -1
    v_mov_b32 v55, -1
    s_mul_i32 s48, s30, 3072
    v_lshl_add_u32 v12, v0, 4, s48
    global_store_dwordx4 v12, v[52:55], s[14:15] offset:0
    global_store_dwordx4 v12, v[52:55], s[14:15] offset:1024
    global_store_dwordx4 v12, v[52:55], s[14:15] offset:2048
    s_waitcnt lgkmcnt(0)
    s_getreg_b32 s49, hwreg(HW_REG_XCC_ID, 0, 3)
    s_and_b32 s24, s42, 0xff
    s_cmp_eq_u32 s24, 0xfe
    s_addc_u32 s43, s42, 1
    s_and_b32 s24, s43, 0xff
    s_and_b32 s42, s43, 0x1fffffff
    s_lshl_b32 s49, s49, 29
    s_or_b32 s42, s42, s49
    s_lshl_b32 s48, s29, 9
    s_lshl_b32 s59, s30, 4
    s_add_u32 s48, s48, s59
    s_add_u32 s48, s48, 1310720
    v_mov_b32 v14, s48
    v_mov_b32 v20, s42
    s_mov_b64 exec, 0x1
    s_waitcnt vmcnt(0)
    global_store_dword v14, v20, s[26:27] sc1
    s_mov_b64 exec, -1
L_noclr:
    s_mov_b32 s32, 0
    s_mov_b32 s33, 0x200000
    s_mov_b32 s34, 2
    s_lshr_b32 s35, s30, 3
    s_and_b32 s36, s30, 7
    s_cmp_lt_u32 s29, 6
    s_cselect_b32 s25, 7, 6
    s_mov_b32 s44, 0x05040100
    s_mov_b32 s45, 0x07060302
    s_mov_b32 s6, 0xf000f
    s_mov_b32 s7, s6
    s_mov_b32 s8, 0xff00ff
    s_mov_b32 s9, s8
    v_lshlrev_b32 v11, 2, v0
    v_mov_b32 v30, 0xff
    v_and_b32 v12, 1, v0
    v_mul_u32_u24 v1, 0xaaaa, v12
    v_add_u32 v1, 0x4444, v1
    v_mul_u32_u24 v2, 0x5555, v12
    v_add_u32 v2, 0x8888, v2
    v_lshlrev_b32 v9, 4, v12
    v_lshl_add_u32 v9, v26, 5, v9
    v_mov_b32 v4, 0x3f803f80
    v_mov_b32 v5, 0x3f803f80
    v_mov_b32 v6, 0x3f803f80
    v_mov_b32 v7, 0x3f803f80
    v_lshrrev_b32 v8, 5, v0
    v_lshlrev_b32 v8, 4, v8
    v_and_b32 v12, 1, v26
    v_lshl_add_u32 v8, v12, 2, v8
    v_bfe_u32 v12, v0, 2, 1
    v_add_u32 v8, v8, v12
    v_and_b32 v12, 8, v0
    v_add_u32 v8, v8, v12
    v_mov_b64 v[32:33], 0
    v_mov_b64 v[34:35], 0
    v_mov_b64 v[36:37], 0
    v_mov_b64 v[38:39], 0
    v_mov_b64 v[40:41], 0
    v_mov_b64 v[42:43], 0
    v_mov_b64 v[44:45], 0
    v_mov_b64 v[46:47], 0
    s_cmp_eq_u32 s28, 7
    s_cbranch_scc1 L_hep
    s_waitcnt lgkmcnt(0)
    s_getreg_b32 s49, hwreg(HW_REG_XCC_ID, 0, 3)
    s_and_b32 s24, s42, 0xff
    s_cmp_eq_u32 s24, 0xfe
    s_addc_u32 s43, s42, 1
    s_and_b32 s24, s43, 0xff
    s_and_b32 s42, s43, 0x1fffffff
    s_lshl_b32 s49, s49, 29
    s_or_b32 s42, s42, s49
    s_waitcnt vmcnt(0)
L_hep:
    s_add_u32 s48, s3, s37
    s_lshl3_add_u32 s48, s48, s31
    s_cmp_lt_u32 s48, 8
    s_cbranch_scc1 L_vote
    s_cmp_lg_u32 s37, 2
    s_cbranch_scc1 L_hand
    s_lshl_b32 s48, s3, 11
    s_add_u32 s48, s48, 98304
    v_lshl_add_u32 v12, v0, 4, s48
    ds_write_b128 v12, v[32:35]
    ds_write_b128 v12, v[32:35] offset:1024
    v_dot2_f32_bf16 v73, v68, v68, 0
    v_dot2_f32_bf16 v74, v68, v4, 0
    v_dot2_f32_bf16 v73, v69, v69, v73
    v_dot2_f32_bf16 v74, v69, v4, v74
    v_dot2_f32_bf16 v73, v70, v70, v73
    v_dot2_f32_bf16 v74, v70, v4, v74
    v_dot2_f32_bf16 v73, v71, v71, v73
    v_dot2_f32_bf16 v74, v71, v4, v74
    v_dot2_f32_bf16 v73, v72, v72, v73
    v_dot2_f32_bf16 v74, v72, v4, v74
    s_nop 2
    v_permlane32_swap_b32 v73, v74
    v_add_f32 v73, v73, v74
    s_nop 1
    v_add_f32_dpp v73, v73, v73 row_ror:8 row_mask:0xf bank_mask:0xf
    s_nop 1
    v_add_f32_dpp v73, v73, v73 row_ror:4 row_mask:0xf bank_mask:0xf
    s_nop 1
    v_add_f32_dpp v73, v73, v73 row_ror:2 row_mask:0xf bank_mask:0xf
    s_nop 1
    v_add_f32_dpp v73, v73, v73 row_ror:1 row_mask:0xf bank_mask:0xf
    s_nop 1
    v_add_f32_dpp v73, v73, v73 row_bcast:15 row_mask:0xa bank_mask:0xf
    v_mul_f32 v73, 0x3acccccd, v73
    s_nop 0
    v_readlane_b32 s50, v73, 48
    v_readlane_b32 s51, v73, 16
    s_nop 0
    v_mov_b32 v74, s50
    v_fma_f32 v74, -v74, v74, s51
    v_max_f32 v74, 0, v74
    v_add_f32 v74, 0x3727c5ac, v74
    v_rsq_f32 v74, v74
    v_lshlrev_b32 v68, 16, v64
    v_and_b32 v69, 0xffff0000, v64
    v_subrev_f32 v68, s50, v68
    v_subrev_f32 v69, s50, v69
    v_mul_f32 v68, v68, v74
    v_mul_f32 v69, v69, v74
    v_cvt_pk_bf16_f32 v60, v68, v69
    v_lshlrev_b32 v68, 16, v65
    v_and_b32 v69, 0xffff0000, v65
    v_subrev_f32 v68, s50, v68
    v_subrev_f32 v69, s50, v69
    v_mul_f32 v68, v68, v74
    v_mul_f32 v69, v69, v74
    v_cvt_pk_bf16_f32 v61, v68, v69
    v_lshlrev_b32 v68, 16, v66
    v_and_b32 v69, 0xffff0000, v66
    v_subrev_f32 v68, s50, v68
    v_subrev_f32 v69, s50, v69
    v_mul_f32 v68, v68, v74
    v_mul_f32 v69, v69, v74
    v_cvt_pk_bf16_f32 v62, v68, v69
    v_lshlrev_b32 v68, 16, v67
    v_and_b32 v69, 0xffff0000, v67
    v_subrev_f32 v68, s50, v68
    v_subrev_f32 v69, s50, v69
    v_mul_f32 v68, v68, v74
    v_mul_f32 v69, v69, v74
    v_cvt_pk_bf16_f32 v63, v68, v69
    s_mov_b32 exec_lo, 0xcccccccc
    s_mov_b32 exec_hi, 0xcccccccc
    v_mov_b32 v60, v4
    v_mov_b32 v61, v4
    v_mov_b32 v62, v4
    v_mov_b32 v63, v4
    s_mov_b64 exec, -1
    s_lshl_b32 s47, s3, 1
    s_barrier
L_q1l:
    v_lshrrev_b32 v13, 1, v8
    v_and_b32 v13, 6, v13
    v_and_or_b32 v13, v8, 1, v13
    v_lshlrev_b32 v13, 5, v13
    s_and_b32 s48, s47, 1
    s_lshr_b32 s49, s47, 1
    s_lshl_b32 s48, s48, 7
    s_lshl_b32 s59, s49, 14
    s_add_u32 s48, s48, s59
    v_xor_b32 v13, s48, v13
    v_lshl_add_u32 v12, v8, 8, v13
    v_and_b32 v13, 3, v0
    v_lshl_add_u32 v12, v13, 3, v12
    ds_read_b64_tr_b16 v[96:97], v12 offset:8192
    ds_read_b64_tr_b16 v[98:99], v12 offset:8704
    ds_read_b64_tr_b16 v[100:101], v12 offset:16384
    ds_read_b64_tr_b16 v[102:103], v12 offset:16896
    v_xor_b32 v13, 32, v12
    ds_read_b64_tr_b16 v[104:105], v13 offset:8192
    ds_read_b64_tr_b16 v[106:107], v13 offset:8704
    ds_read_b64_tr_b16 v[108:109], v13 offset:16384
    ds_read_b64_tr_b16 v[110:111], v13 offset:16896
    v_xor_b32 v13, 64, v12
    ds_read_b64_tr_b16 v[112:113], v13 offset:8192
    ds_read_b64_tr_b16 v[114:115], v13 offset:8704
    ds_read_b64_tr_b16 v[116:117], v13 offset:16384
    ds_read_b64_tr_b16 v[118:119], v13 offset:16896
    v_xor_b32 v13, 96, v12
    ds_read_b64_tr_b16 v[120:121], v13 offset:8192
    ds_read_b64_tr_b16 v[122:123], v13 offset:8704
    ds_read_b64_tr_b16 v[124:125], v13 offset:16384
    ds_read_b64_tr_b16 v[126:127], v13 offset:16896
    v_mov_b64 v[64:65], 0
    v_mov_b64 v[66:67], 0
    v_mov_b64 v[68:69], 0
    v_mov_b64 v[70:71], 0
    v_mov_b64 v[72:73], 0
    v_mov_b64 v[74:75], 0
    v_mov_b64 v[76:77], 0
    v_mov_b64 v[78:79], 0
    s_mul_i32 s48, s47, 5120
    s_lshl_b32 s59, s31, 8
    s_add_u32 s48, s48, s59
    s_add_u32 s48, s48, 98304
    v_add_u32 v14, s48, v11
    s_waitcnt lgkmcnt(0)
    v_smfmac_f32_16x16x64_bf16 v[64:67], v[60:63], v[96:103], v1
    v_smfmac_f32_16x16x64_bf16 v[68:71], v[60:63], v[104:111], v1
    v_smfmac_f32_16x16x64_bf16 v[72:75], v[60:63], v[112:119], v1
    v_smfmac_f32_16x16x64_bf16 v[76:79], v[60:63], v[120:127], v1
    s_nop 4
    v_add_f32 v80, v64, v65
    v_add_f32 v81, v66, v67
    s_mov_b32 exec_lo, 0xffff0000
    v_add_f32 v80, v68, v69
    v_add_f32 v81, v70, v71
    s_mov_b32 exec_lo, 0
    v_add_f32 v80, v72, v73
    v_add_f32 v81, v74, v75
    s_mov_b32 exec_hi, 0xffff0000
    v_add_f32 v80, v76, v77
    v_add_f32 v81, v78, v79
    s_mov_b64 exec, -1
    v_bfi_b32 v80, v30, s43, v80
    v_bfi_b32 v81, v30, s43, v81
    global_store_dword v14, v80, s[14:15]
    global_store_dword v14, v81, s[14:15] offset:2560
    s_add_u32 s47, s47, 1
    s_bitcmp1_b32 s47, 0
    s_cbranch_scc1 L_q1l
L_hand:
    s_setprio 0
    s_waitcnt vmcnt(0)
L_hand2:
    s_barrier
    global_load_dwordx4 v[128:131], v27, s[38:39] offset:0 nt
    s_nop 0
    global_load_dwordx4 v[132:135], v27, s[38:39] offset:128 nt
    v_xor_b32 v27, 262144, v27
    global_load_dwordx4 v[136:139], v27, s[38:39] offset:0 nt
    s_nop 0
    global_load_dwordx4 v[140:143], v27, s[38:39] offset:128 nt
    v_xor_b32 v27, 278528, v27
    global_load_dwordx4 v[144:147], v27, s[38:39] offset:0 nt
    s_nop 0
    global_load_dwordx4 v[148:151], v27, s[38:39] offset:128 nt
    v_xor_b32 v27, 262144, v27
    s_waitcnt vmcnt(5)
    s_branch L_kv
L_cold:
L_rm_40:
    s_add_u32 s47, s47, 1
    s_cmp_lg_u32 s47, 1
    s_cbranch_scc1 L_rn_50
    global_load_dword v48, v21, s[14:15] sc1
    global_load_dword v49, v20, s[94:95] offset:256 sc1
    global_load_dword v50, v20, s[94:95] offset:512 sc1
    global_load_dword v51, v20, s[94:95] offset:768 sc1
    global_load_dword v52, v20, s[94:95] offset:1024 sc1
    global_load_dword v53, v20, s[94:95] offset:1280 sc1
    global_load_dword v54, v20, s[94:95] offset:1536 sc1
    global_load_dword v55, v20, s[94:95] offset:1792 sc1
    s_cmp_lg_u32 s32, 0
    s_waitcnt vmcnt(16)
    s_branch L_try_39
L_rn_50:
    s_cmp_lg_u32 s47, 2
    s_cbranch_scc1 L_rn_51
    s_cmp_lg_u32 s32, 0
    s_waitcnt vmcnt(8)
    s_branch L_try_39
L_rn_51:
    s_cmp_lg_u32 s47, 3
    s_cbranch_scc1 L_rn_52
    s_cmp_lg_u32 s32, 0
    s_waitcnt vmcnt(0)
    s_branch L_try_39
L_rn_52:
L_fb_36:
L_rf_53:
    global_load_dword v48, v21, s[14:15] sc1
    global_load_dword v49, v20, s[94:95] offset:256 sc1
    global_load_dword v50, v20, s[94:95] offset:512 sc1
    global_load_dword v51, v20, s[94:95] offset:768 sc1
    global_load_dword v52, v20, s[94:95] offset:1024 sc1
    global_load_dword v53, v20, s[94:95] offset:1280 sc1
    global_load_dword v54, v20, s[94:95] offset:1536 sc1
    global_load_dword v55, v20, s[94:95] offset:1792 sc1
    s_sub_u32 s33, s33, 1
    s_cbranch_scc1 L_exit
    s_waitcnt vmcnt(0)
    v_xor_b32 v75, s24, v48
    v_bitop3_b32 v75, v49, s24, v75 bitop3:0xbe
    v_bitop3_b32 v75, v50, s24, v75 bitop3:0xbe
    v_bitop3_b32 v75, v51, s24, v75 bitop3:0xbe
    v_bitop3_b32 v75, v52, s24, v75 bitop3:0xbe
    v_bitop3_b32 v75, v53, s24, v75 bitop3:0xbe
    v_bitop3_b32 v75, v54, s24, v75 bitop3:0xbe
    v_bitop3_b32 v75, v55, s24, v75 bitop3:0xbe
    v_and_b32 v75, 0xff, v75
    v_cmp_ne_u32 vcc, 0, v75
    s_cmp_lg_u32 s32, 0
    s_cbranch_vccz L_try_39
    s_branch L_rf_53
L_gr_29:
    global_load_dword v62, v12, s[14:15] offset:0 sc1
    global_load_dword v63, v12, s[14:15] offset:256 sc1
    global_load_dword v66, v12, s[14:15] offset:512 sc1
    global_load_dword v67, v12, s[14:15] offset:768 sc1
    global_load_dword v70, v12, s[14:15] offset:1024 sc1
    global_load_dword v71, v12, s[14:15] offset:1280 sc1
    global_load_dword v74, v12, s[14:15] offset:1536 sc1
    global_load_dword v75, v12, s[14:15] offset:1792 sc1
    global_load_dword v78, v12, s[14:15] offset:2048 sc1
    global_load_dword v79, v12, s[14:15] offset:2304 sc1
    s_sub_u32 s33, s33, 1
    s_cbranch_scc1 L_exit
    s_branch L_gc_30
L_q0:
    s_mul_i32 s48, s28, 768
    s_add_u32 s48, s48, 157696
    v_add_u32 v29, s48, v11
    s_mov_b32 s47, 4
    s_lshl_b32 s50, s28, 2
    s_lshl_b32 s48, s50, 10
    s_add_u32 s48, s48, 73728
    s_mov_b32 m0, s48
    v_lshrrev_b32 v12, 3, v0
    v_mul_u32_u24 v12, 1280, v12
    v_and_b32 v13, 7, v0
    v_lshlrev_b32 v13, 4, v13
    v_and_b32 v14, 32, v0
    v_xor_b32 v13, v13, v14
    v_add_u32 v12, v12, v13
    s_and_b32 s48, s50, 1
    s_lshl_b32 s48, s48, 6
    v_xor_b32 v12, s48, v12
    s_mul_i32 s49, s29, 7
    s_min_u32 s49, s49, 48
    s_mul_i32 s48, s49, 40960
    s_mul_i32 s59, s50, 10240
    s_add_u32 s48, s48, s59
    s_lshl_b32 s59, s31, 7
    s_add_u32 s48, s48, s59
    v_add_u32 v12, s48, v12
    s_barrier
    s_cmp_ge_u32 s28, s25
    s_cbranch_scc1 L_q0b
    s_add_u32 s48, s28, 0
    s_cmp_ge_u32 s48, s25
    s_cbranch_scc1 L_rq1
    s_mov_b32 s58, 10240
L_dma_54:
    global_load_lds_dwordx4 v12, s[20:21] nt
    s_add_u32 m0, m0, 1024
    v_xad_u32 v12, v12, 64, s58
    s_sub_u32 s47, s47, 1
    s_cmp_lg_u32 s47, 0
    s_cbranch_scc1 L_dma_54
    s_branch L_rq1
L_q0b:
    s_cmp_eq_u32 s28, 7
    s_cbranch_scc1 L_rq1
    s_barrier
    s_branch L_rq1
L_w2f:
    global_load_dword v10, v29, s[14:15] sc1
    s_mov_b64 exec, s[38:39]
    global_load_dword v90, v13, s[14:15] sc1
    s_mov_b64 exec, -1
    s_waitcnt vmcnt(0)
    s_barrier
    s_cmp_ge_u32 s28, 4
    s_cbranch_scc1 L_w2c
    ds_read_b64_tr_b16 v[96:97], v22 offset:0
    ds_read_b64_tr_b16 v[98:99], v22 offset:256
    ds_read_b64_tr_b16 v[100:101], v22 offset:4096
    ds_read_b64_tr_b16 v[102:103], v22 offset:4352
    ds_read_b64_tr_b16 v[104:105], v22 offset:8192
    ds_read_b64_tr_b16 v[106:107], v22 offset:8448
    ds_read_b64_tr_b16 v[108:109], v22 offset:12288
    ds_read_b64_tr_b16 v[110:111], v22 offset:12544
    ds_read_b64_tr_b16 v[112:113], v22 offset:16384
    ds_read_b64_tr_b16 v[114:115], v22 offset:16640
    ds_read_b64_tr_b16 v[116:117], v22 offset:20480
    ds_read_b64_tr_b16 v[118:119], v22 offset:20736
    ds_read_b64_tr_b16 v[120:121], v22 offset:24576
    ds_read_b64_tr_b16 v[122:123], v22 offset:24832
    ds_read_b64_tr_b16 v[124:125], v22 offset:28672
    ds_read_b64_tr_b16 v[126:127], v22 offset:28928
L_w2c:
    v_xor_b32 v10, s24, v10
    v_and_b32 v28, 0xff, v10
    v_cmp_ne_u32 vcc, 0, v28
    s_cbranch_vccnz L_w2d
    v_cmp_eq_u32 vcc, -1, v90
    s_cbranch_vccz L_hgo
    s_branch L_w2r
L_w2d:
    global_load_dword v10, v29, s[14:15] sc1
    s_sub_u32 s33, s33, 1
    s_cbranch_scc1 L_exit
    s_waitcnt vmcnt(0)
    s_branch L_w2c
L_rm_23:
    s_add_u32 s47, s47, 1
    s_cmp_lg_u32 s47, 1
    s_cbranch_scc1 L_rn_55
    global_load_dword v48, v21, s[14:15] sc1
    global_load_dword v49, v20, s[94:95] offset:256 sc1
    global_load_dword v50, v20, s[94:95] offset:512 sc1
    global_load_dword v51, v20, s[94:95] offset:768 sc1
    global_load_dword v52, v20, s[94:95] offset:1024 sc1
    global_load_dword v53, v20, s[94:95] offset:1280 sc1
    global_load_dword v54, v20, s[94:95] offset:1536 sc1
    global_load_dword v55, v20, s[94:95] offset:1792 sc1
    s_waitcnt vmcnt(16)
    s_branch L_try_22
L_rn_55:
    s_cmp_lg_u32 s47, 2
    s_cbranch_scc1 L_rn_56
    s_waitcnt vmcnt(8)
    s_branch L_try_22
L_rn_56:
    s_cmp_lg_u32 s47, 3
    s_cbranch_scc1 L_rn_57
    s_waitcnt vmcnt(0)
    s_branch L_try_22
L_rn_57:
L_fb_18:
    global_load_dword v48, v21, s[14:15] sc1
    global_load_dword v49, v20, s[94:95] offset:256 sc1
    global_load_dword v50, v20, s[94:95] offset:512 sc1
    global_load_dword v51, v20, s[94:95] offset:768 sc1
    global_load_dword v52, v20, s[94:95] offset:1024 sc1
    global_load_dword v53, v20, s[94:95] offset:1280 sc1
    global_load_dword v54, v20, s[94:95] offset:1536 sc1
    global_load_dword v55, v20, s[94:95] offset:1792 sc1
    s_nop 8
L_rf_58:
    global_load_dword v48, v21, s[14:15] sc1
    global_load_dword v49, v20, s[94:95] offset:256 sc1
    global_load_dword v50, v20, s[94:95] offset:512 sc1
    global_load_dword v51, v20, s[94:95] offset:768 sc1
    global_load_dword v52, v20, s[94:95] offset:1024 sc1
    global_load_dword v53, v20, s[94:95] offset:1280 sc1
    global_load_dword v54, v20, s[94:95] offset:1536 sc1
    global_load_dword v55, v20, s[94:95] offset:1792 sc1
    s_sub_u32 s33, s33, 1
    s_cbranch_scc1 L_exit
    s_waitcnt vmcnt(8)
    v_xor_b32 v75, s24, v48
    v_bitop3_b32 v75, v49, s24, v75 bitop3:0xbe
    v_bitop3_b32 v75, v50, s24, v75 bitop3:0xbe
    v_bitop3_b32 v75, v51, s24, v75 bitop3:0xbe
    v_bitop3_b32 v75, v52, s24, v75 bitop3:0xbe
    v_bitop3_b32 v75, v53, s24, v75 bitop3:0xbe
    v_bitop3_b32 v75, v54, s24, v75 bitop3:0xbe
    v_bitop3_b32 v75, v55, s24, v75 bitop3:0xbe
    v_and_b32 v75, 0xff, v75
    v_cmp_ne_u32 vcc, 0, v75
    s_cbranch_vccz L_try_22
    s_branch L_rf_58
L_f0:
    v_mul_u32_u24 v12, 448, v8
    v_and_b32 v13, 3, v0
    v_lshl_add_u32 v12, v13, 3, v12
    s_lshl_b32 s48, s28, 6
    s_add_u32 s48, s48, 8192
    v_add_u32 v12, s48, v12
    ds_read_b64_tr_b16 v[96:97], v12 offset:0
    ds_read_b64_tr_b16 v[98:99], v12 offset:896
    ds_read_b64_tr_b16 v[100:101], v12 offset:14336
    ds_read_b64_tr_b16 v[102:103], v12 offset:15232
    ds_read_b64_tr_b16 v[104:105], v12 offset:32
    ds_read_b64_tr_b16 v[106:107], v12 offset:928
    ds_read_b64_tr_b16 v[108:109], v12 offset:14368
    ds_read_b64_tr_b16 v[110:111], v12 offset:15264
    ds_read_b64_tr_b16 v[112:113], v12 offset:28672
    ds_read_b64_tr_b16 v[114:115], v12 offset:29568
    ds_read_b64_tr_b16 v[116:117], v12 offset:43008
    ds_read_b64_tr_b16 v[118:119], v12 offset:43904
    ds_read_b64_tr_b16 v[120:121], v12 offset:28704
    ds_read_b64_tr_b16 v[122:123], v12 offset:29600
    ds_read_b64_tr_b16 v[124:125], v12 offset:43040
    ds_read_b64_tr_b16 v[126:127], v12 offset:43936
    v_mov_b64 v[64:65], 0
    v_mov_b64 v[68:69], 0
    v_mov_b64 v[72:73], 0
    v_mov_b64 v[76:77], 0
    s_add_u32 s48, s52, 139264
    v_add_u32 v14, s48, v11
    s_waitcnt lgkmcnt(0)
    v_smfmac_f32_16x16x64_bf16 v[64:67], v[4:7], v[96:103], v1
    v_smfmac_f32_16x16x64_bf16 v[68:71], v[4:7], v[104:111], v1
    v_smfmac_f32_16x16x64_bf16 v[72:75], v[4:7], v[112:119], v1
    v_smfmac_f32_16x16x64_bf16 v[76:79], v[4:7], v[120:127], v1
    s_cmp_lg_u32 s34, 1
    s_nop 3
    v_add_f32 v80, v64, v65
    s_mov_b32 exec_lo, 0xffff0000
    v_add_f32 v80, v68, v69
    s_mov_b32 exec_lo, 0
    v_add_f32 v80, v72, v73
    s_mov_b32 exec_hi, 0xffff0000
    v_add_f32 v80, v76, v77
    s_mov_b64 exec, -1
    v_bfi_b32 v80, v30, s43, v80
    s_cbranch_scc1 L_slow_59
    global_store_dword v14, v80, s[14:15]
L_st_60:
    s_branch L_f1
L_fidle:
    s_barrier
    s_branch L_next
L_wor:
    global_load_dwordx4 v[60:63], v25, s[14:15] sc1
    s_sub_u32 s33, s33, 1
    s_cbranch_scc1 L_exit
    s_branch L_woc
L_w3:
    s_waitcnt vmcnt(1)
    v_cmp_eq_u32 vcc, -1, v28
    s_cbranch_vccz L_wgo
    s_branch L_wos
L_w0:
    s_lshl_b32 s48, s28, 13
    s_add_u32 s48, s48, 8192
    v_lshlrev_b32 v16, 7, v8
    v_bfe_u32 v17, v8, 2, 2
    v_lshl_add_u32 v16, v17, 5, v16
    v_and_b32 v17, 3, v0
    v_lshl_add_u32 v16, v17, 3, v16
    v_add_u32 v16, s48, v16
    ds_read_b64_tr_b16 v[96:97], v16 offset:0
    ds_read_b64_tr_b16 v[98:99], v16 offset:256
    ds_read_b64_tr_b16 v[100:101], v16 offset:4096
    ds_read_b64_tr_b16 v[102:103], v16 offset:4352
    v_xor_b32 v17, 32, v16
    ds_read_b64_tr_b16 v[104:105], v17 offset:0
    ds_read_b64_tr_b16 v[106:107], v17 offset:256
    ds_read_b64_tr_b16 v[108:109], v17 offset:4096
    ds_read_b64_tr_b16 v[110:111], v17 offset:4352
    v_xor_b32 v17, 64, v16
    ds_read_b64_tr_b16 v[112:113], v17 offset:0
    ds_read_b64_tr_b16 v[114:115], v17 offset:256
    ds_read_b64_tr_b16 v[116:117], v17 offset:4096
    ds_read_b64_tr_b16 v[118:119], v17 offset:4352
    v_xor_b32 v17, 96, v16
    ds_read_b64_tr_b16 v[120:121], v17 offset:0
    ds_read_b64_tr_b16 v[122:123], v17 offset:256
    ds_read_b64_tr_b16 v[124:125], v17 offset:4096
    ds_read_b64_tr_b16 v[126:127], v17 offset:4352
    s_branch L_wos
L_cstat0:
    s_setprio 1
    s_lshl_b32 s48, s32, 7
    v_and_b32 v23, 124, v11
    v_add_u32 v23, s48, v23
L_cstat:
    ds_read_b32 v77, v23 offset:1792
    ds_read_b32 v76, v20
    s_sub_u32 s33, s33, 1
    s_cbranch_scc1 L_exit
    s_waitcnt lgkmcnt(0)
    v_cmp_eq_u32 vcc, -1, v77
    v_max_f32_dpp v78, v76, v76 quad_perm:[1,0,3,2] row_mask:0xf bank_mask:0xf
    v_add_f32_dpp v77, v77, v77 row_ror:8 row_mask:0xf bank_mask:0xf
    s_cbranch_vccnz L_cstat
    v_max_f32_dpp v78, v78, v78 quad_perm:[2,3,0,1] row_mask:0xf bank_mask:0xf
    v_mov_b32 v79, v77
    s_cmp_lg_u32 s34, 1
    v_max_f32_dpp v78, v78, v78 row_half_mirror row_mask:0xf bank_mask:0xf
    v_permlane16_swap_b32 v77, v79
    v_sub_f32 v76, v76, v78
    v_exp_f32 v76, v76
    v_add_f32 v77, v77, v79
    v_mul_f32 v77, v76, v77
    s_nop 1
    v_add_f32_dpp v77, v77, v77 quad_perm:[1,0,3,2] row_mask:0xf bank_mask:0xf
    s_nop 1
    v_add_f32_dpp v77, v77, v77 quad_perm:[2,3,0,1] row_mask:0xf bank_mask:0xf
    s_nop 1
    v_add_f32_dpp v78, v77, v77 row_half_mirror row_mask:0xc bank_mask:0xf
    s_mov_b32 exec_lo, 0xf
    s_mov_b32 exec_hi, 0xf
    s_cbranch_scc1 L_slow_61
    global_store_dword v22, v78, s[14:15]
L_st_62:
    s_mov_b64 exec, -1
    s_branch L_nocomb
L_gr_4:
    global_load_dword v62, v16, s[14:15] offset:0 sc1
    global_load_dword v63, v16, s[14:15] offset:256 sc1
    global_load_dword v66, v16, s[14:15] offset:512 sc1
    global_load_dword v67, v16, s[14:15] offset:768 sc1
    global_load_dword v70, v16, s[14:15] offset:1024 sc1
    global_load_dword v71, v16, s[14:15] offset:1280 sc1
    global_load_dword v74, v16, s[14:15] offset:1536 sc1
    global_load_dword v75, v16, s[14:15] offset:1792 sc1
    global_load_dword v78, v16, s[14:15] offset:2048 sc1
    global_load_dword v79, v16, s[14:15] offset:2304 sc1
    s_sub_u32 s33, s33, 1
    s_cbranch_scc1 L_exit
    s_branch L_gc_5
L_e0:
    ds_read_b96 v[16:18], v13 offset:0
    s_sub_u32 s33, s33, 1
    s_cbranch_scc1 L_exit
    s_waitcnt lgkmcnt(0)
    v_max3_u32 v16, v16, v17, v18
    v_cmp_eq_u32 vcc, -1, v16
    s_mov_b64 exec, s[6:7]
    s_cbranch_vccz L_attc
    s_mov_b64 exec, -1
    s_sleep 2
    s_branch L_e0
L_e0b:
    s_barrier
    s_cmp_lg_u32 s37, 0
    s_cbranch_scc1 L_e0c
    s_lshl_b32 s48, s28, 13
    s_add_u32 s48, s48, 8192
    v_lshlrev_b32 v16, 7, v8
    v_bfe_u32 v17, v8, 2, 2
    v_lshl_add_u32 v16, v17, 5, v16
    v_and_b32 v17, 3, v0
    v_lshl_add_u32 v16, v17, 3, v16
    v_add_u32 v16, s48, v16
    ds_read_b64_tr_b16 v[96:97], v16 offset:0
    ds_read_b64_tr_b16 v[98:99], v16 offset:256
    ds_read_b64_tr_b16 v[100:101], v16 offset:4096
    ds_read_b64_tr_b16 v[102:103], v16 offset:4352
    v_xor_b32 v17, 32, v16
    ds_read_b64_tr_b16 v[104:105], v17 offset:0
    ds_read_b64_tr_b16 v[106:107], v17 offset:256
    ds_read_b64_tr_b16 v[108:109], v17 offset:4096
    ds_read_b64_tr_b16 v[110:111], v17 offset:4352
    v_xor_b32 v17, 64, v16
    ds_read_b64_tr_b16 v[112:113], v17 offset:0
    ds_read_b64_tr_b16 v[114:115], v17 offset:256
    ds_read_b64_tr_b16 v[116:117], v17 offset:4096
    ds_read_b64_tr_b16 v[118:119], v17 offset:4352
    v_xor_b32 v17, 96, v16
    ds_read_b64_tr_b16 v[120:121], v17 offset:0
    ds_read_b64_tr_b16 v[122:123], v17 offset:256
    ds_read_b64_tr_b16 v[124:125], v17 offset:4096
    ds_read_b64_tr_b16 v[126:127], v17 offset:4352
L_e0c:
    s_cmp_ge_u32 s28, 2
    s_cbranch_scc1 L_e0r
    s_mul_i32 s48, s35, 1536
    s_mul_i32 s59, s28, 768
    s_add_u32 s48, s48, s59
    s_add_u32 s48, s48, 157440
    v_add_u32 v18, s48, v11
L_pp_63:
    global_load_dword v3, v18, s[14:15] sc1
    s_sub_u32 s33, s33, 1
    s_cbranch_scc1 L_exit
    s_waitcnt vmcnt(0)
    v_xor_b32 v3, s24, v3
    v_and_b32 v19, 0xff, v3
    v_cmp_ne_u32 vcc, 0, v19
    s_cbranch_vccnz L_pp_63
    s_branch L_e0r
L_n0:
    s_lshl2_add_u32 s47, s31, s3
    s_mul_i32 s48, s47, 5120
    s_add_u32 s48, s48, 100864
    v_add_u32 v16, s48, v11
    s_mul_i32 s48, s47, 768
    s_add_u32 s48, s48, 157184
    v_add_u32 v18, s48, v11
    s_lshl_b32 s48, s29, 9
    s_add_u32 s48, s48, 1310720
    v_and_b32 v20, 31, v0
    v_lshl_add_u32 v20, v20, 4, s48
    global_load_dword v92, v18, s[14:15] sc1
L_n0l:
    global_load_dword v60, v16, s[14:15] offset:-2560 sc1
    global_load_dword v61, v16, s[14:15] offset:-2304 sc1
    global_load_dword v62, v16, s[14:15] offset:-2048 sc1
    global_load_dword v63, v16, s[14:15] offset:-1792 sc1
    global_load_dword v64, v16, s[14:15] offset:-1536 sc1
    global_load_dword v65, v16, s[14:15] offset:-1280 sc1
    global_load_dword v66, v16, s[14:15] offset:-1024 sc1
    global_load_dword v67, v16, s[14:15] offset:-768 sc1
    global_load_dword v68, v16, s[14:15] offset:-512 sc1
    global_load_dword v69, v16, s[14:15] offset:-256 sc1
    global_load_dword v90, v20, s[26:27] sc1
    s_sub_u32 s33, s33, 1
    s_cbranch_scc1 L_exit
    s_waitcnt vmcnt(0)
    v_xor_b32 v60, s24, v60
    v_xor_b32 v61, s24, v61
    v_xor_b32 v62, s24, v62
    v_xor_b32 v63, s24, v63
    v_xor_b32 v64, s24, v64
    v_xor_b32 v65, s24, v65
    v_xor_b32 v66, s24, v66
    v_xor_b32 v67, s24, v67
    v_xor_b32 v68, s24, v68
    v_xor_b32 v69, s24, v69
    v_or3_b32 v19, v60, v61, v62
    v_or3_b32 v19, v19, v63, v64
    v_or3_b32 v19, v19, v65, v66
    v_or3_b32 v19, v19, v67, v68
    v_bitop3_b32 v19, v19, v69, v30 bitop3:0xa8
    v_cmp_ne_u32 vcc, 0, v19
    s_cbranch_vccnz L_n0l
    v_xor_b32 v90, s42, v90
    v_lshlrev_b32 v91, 3, v90
    v_cmp_ne_u32 vcc, 0, v91
    s_cbranch_vccnz L_n0l
    v_pk_add_f32 v[60:61], v[60:61], v[62:63]
    v_pk_add_f32 v[60:61], v[60:61], v[64:65]
    v_pk_add_f32 v[60:61], v[60:61], v[66:67]
    v_pk_add_f32 v[60:61], v[60:61], v[68:69]
    v_add_f32 v60, v60, v61
    v_bfi_b32 v60, v30, s43, v60
    v_cmp_ne_u32 vcc, 0, v90
    s_nop 0
    s_cmp_lg_u32 vcc_lo, 0
    s_cselect_b32 s34, 2, 1
    s_cbranch_scc1 L_slow_64
    global_store_dword v18, v60, s[14:15]
L_st_65:
    global_load_dword v92, v18, s[14:15] offset:256 sc1
    global_load_dword v92, v18, s[14:15] offset:512 sc1
L_n1l:
    global_load_dword v70, v16, s[14:15] offset:0 sc1
    global_load_dword v71, v16, s[14:15] offset:256 sc1
    global_load_dword v72, v16, s[14:15] offset:512 sc1
    global_load_dword v73, v16, s[14:15] offset:768 sc1
    global_load_dword v74, v16, s[14:15] offset:1024 sc1
    global_load_dword v75, v16, s[14:15] offset:1280 sc1
    global_load_dword v76, v16, s[14:15] offset:1536 sc1
    global_load_dword v77, v16, s[14:15] offset:1792 sc1
    global_load_dword v78, v16, s[14:15] offset:2048 sc1
    global_load_dword v79, v16, s[14:15] offset:2304 sc1
    s_sub_u32 s33, s33, 1
    s_cbranch_scc1 L_exit
    s_waitcnt vmcnt(0)
    v_xor_b32 v70, s24, v70
    v_xor_b32 v71, s24, v71
    v_xor_b32 v72, s24, v72
    v_xor_b32 v73, s24, v73
    v_xor_b32 v74, s24, v74
    v_xor_b32 v75, s24, v75
    v_xor_b32 v76, s24, v76
    v_xor_b32 v77, s24, v77
    v_xor_b32 v78, s24, v78
    v_xor_b32 v79, s24, v79
    v_or3_b32 v19, v70, v71, v72
    v_or3_b32 v19, v19, v73, v74
    v_or3_b32 v19, v19, v75, v76
    v_or3_b32 v19, v19, v77, v78
    v_bitop3_b32 v19, v19, v79, v30 bitop3:0xa8
    v_cmp_ne_u32 vcc, 0, v19
    s_cbranch_vccnz L_n1l
    v_pk_add_f32 v[70:71], v[70:71], v[72:73]
    v_pk_add_f32 v[70:71], v[70:71], v[74:75]
    v_pk_add_f32 v[70:71], v[70:71], v[76:77]
    v_pk_add_f32 v[70:71], v[70:71], v[78:79]
    v_add_f32 v70, v70, v71
    v_bfi_b32 v70, v30, s43, v70
    s_cmp_lg_u32 s34, 1
    s_cbranch_scc1 L_slow_66
    global_store_dword v18, v70, s[14:15] offset:256
L_st_67:
    s_branch L_n0r
L_roleN:
    s_cmp_lg_u32 s32, 0
    s_cbranch_scc1 L_exit
    s_barrier
    s_cmp_lt_u32 s28, 4
    s_cbranch_scc1 L_next
    s_lshl2_add_u32 s47, s31, s3
    s_cmp_ge_u32 s47, s25
    s_cbranch_scc1 L_next
    s_mul_i32 s48, s47, 2560
    s_add_u32 s48, s48, 139264
    v_add_u32 v17, s48, v11
    s_mul_i32 s48, s47, 768
    s_add_u32 s48, s48, 157696
    v_add_u32 v18, s48, v11
L_n2l:
    global_load_dword v60, v17, s[14:15] offset:0 sc1
    global_load_dword v61, v17, s[14:15] offset:256 sc1
    global_load_dword v62, v17, s[14:15] offset:512 sc1
    global_load_dword v63, v17, s[14:15] offset:768 sc1
    global_load_dword v64, v17, s[14:15] offset:1024 sc1
    global_load_dword v65, v17, s[14:15] offset:1280 sc1
    global_load_dword v66, v17, s[14:15] offset:1536 sc1
    global_load_dword v67, v17, s[14:15] offset:1792 sc1
    global_load_dword v68, v17, s[14:15] offset:2048 sc1
    global_load_dword v69, v17, s[14:15] offset:2304 sc1
    s_sub_u32 s33, s33, 1
    s_cbranch_scc1 L_exit
    s_waitcnt vmcnt(0)
    v_xor_b32 v60, s24, v60
    v_xor_b32 v61, s24, v61
    v_xor_b32 v62, s24, v62
    v_xor_b32 v63, s24, v63
    v_xor_b32 v64, s24, v64
    v_xor_b32 v65, s24, v65
    v_xor_b32 v66, s24, v66
    v_xor_b32 v67, s24, v67
    v_xor_b32 v68, s24, v68
    v_xor_b32 v69, s24, v69
    v_or3_b32 v19, v60, v61, v62
    v_or3_b32 v19, v19, v63, v64
    v_or3_b32 v19, v19, v65, v66
    v_or3_b32 v19, v19, v67, v68
    v_bitop3_b32 v19, v19, v69, v30 bitop3:0xa8
    v_cmp_ne_u32 vcc, 0, v19
    s_cbranch_vccnz L_n2l
    v_pk_add_f32 v[60:61], v[60:61], v[62:63]
    v_pk_add_f32 v[60:61], v[60:61], v[64:65]
    v_pk_add_f32 v[60:61], v[60:61], v[66:67]
    v_pk_add_f32 v[60:61], v[60:61], v[68:69]
    v_add_f32 v60, v60, v61
    v_bfi_b32 v60, v30, s43, v60
    s_cmp_lg_u32 s34, 1
    s_cbranch_scc1 L_slow_68
    global_store_dword v18, v60, s[14:15]
L_st_69:
    s_branch L_next
L_colde:
L_spread:
    buffer_wbl2 sc1
    s_waitcnt vmcnt(0)
    buffer_inv sc1
    s_waitcnt vmcnt(0)
    s_lshl_b32 s48, s29, 9
    s_lshl_b32 s59, s30, 4
    s_add_u32 s48, s48, s59
    s_add_u32 s48, s48, 1314816
    v_mov_b32 v12, s48
    v_mov_b32 v13, s42
    s_mov_b64 exec, 0x1
    global_store_dword v12, v13, s[26:27] sc1
    s_mov_b64 exec, -1
    v_add_u32 v16, 4096, v16
L_bar2:
    s_sleep 10
    global_load_dword v20, v16, s[26:27] sc1
    s_sub_u32 s33, s33, 1
    s_cbranch_scc1 L_exit
    s_waitcnt vmcnt(0)
    v_xor_b32 v20, s42, v20
    v_lshlrev_b32 v20, 3, v20
    v_cmp_ne_u32 vcc, 0, v20
    s_cbranch_vccnz L_bar2
    s_mov_b64 exec, -1
    v_mov_b32 v21, 2
    s_branch L_mode
L_vote:
    s_lshl3_add_u32 s49, s31, s29
    s_lshl_b32 s50, s49, 7
    s_add_u32 s50, s50, 4145152
    s_add_u32 s51, s50, 8192
    s_load_dword s52, s[26:27], s50 glc
    s_load_dword s53, s[26:27], s51 glc
    s_mov_b32 s47, 0
    s_waitcnt lgkmcnt(0)
    s_memtime s[54:55]
    s_waitcnt lgkmcnt(0)
    s_load_dword s52, s[26:27], s50 glc
    s_waitcnt lgkmcnt(0)
    s_memtime s[56:57]
    s_waitcnt lgkmcnt(0)
    s_sub_u32 s53, s56, s54
    s_memtime s[54:55]
    s_waitcnt lgkmcnt(0)
    s_load_dword s52, s[26:27], s51 glc
    s_waitcnt lgkmcnt(0)
    s_memtime s[56:57]
    s_waitcnt lgkmcnt(0)
    s_sub_u32 s52, s56, s54
    s_cmp_lt_u32 s52, s53
    s_addc_u32 s47, s47, 0
    s_cmp_gt_u32 s47, 0
    s_cselect_b32 s52, 1, 0
    s_lshr_b32 s53, s42, 31
    s_xor_b32 s52, s52, s53
    s_and_b32 s53, s42, 0x9fffffff
    s_lshl_b32 s52, s52, 30
    s_or_b32 s52, s52, s53
    s_lshl_b32 s48, s49, 4
    s_add_u32 s48, s48, 1318912
    v_mov_b32 v14, s48
    v_mov_b32 v20, s52
    s_mov_b64 exec, 0x1
    global_store_dword v14, v20, s[26:27] sc1
    s_mov_b64 exec, -1
    s_setprio 0
    s_branch L_hand2
L_slow_2:
    global_store_dword v26, v92, s[14:15] sc1
    s_branch L_st_3
L_slow_8:
    global_store_dword v21, v64, s[14:15] sc1
    s_branch L_st_9
L_slow_11:
    global_store_dword v19, v84, s[14:15] sc1
    s_branch L_st_12
L_slow_15:
    global_store_dword v14, v92, s[14:15] sc1
    s_branch L_st_16
L_slow_25:
    global_store_dword v25, v76, s[14:15] sc1
    s_branch L_st_26
L_slow_27:
    global_store_dword v24, v74, s[14:15] sc1
    s_branch L_st_28
L_slow_33:
    global_store_dword v15, v94, s[14:15] sc1
    s_branch L_st_34
L_slow_42:
    global_store_dword v25, v76, s[14:15] sc1
    s_branch L_st_43
L_slow_44:
    global_store_dword v14, v92, s[14:15] sc1
    s_branch L_st_45
L_slow_46:
    global_store_dword v24, v74, s[14:15] sc1
    s_branch L_st_47
L_slow_48:
    global_store_dword v15, v92, s[14:15] sc1
    s_branch L_st_49
L_slow_59:
    global_store_dword v14, v80, s[14:15] sc1
    s_branch L_st_60
L_slow_61:
    global_store_dword v22, v78, s[14:15] sc1
    s_branch L_st_62
L_slow_64:
    global_store_dword v18, v60, s[14:15] sc1
    s_branch L_st_65
L_slow_66:
    global_store_dword v18, v70, s[14:15] offset:256 sc1
    s_branch L_st_67
L_slow_68:
    global_store_dword v18, v60, s[14:15] sc1
    s_branch L_st_69
L_exit:
L_end:
    s_endpgm
.section .rodata,"a"
.p2align 6
.amdhsa_kernel interleave_layers__mha_block_cached__glu_gated_swiglu__decode_kernel
  .amdhsa_next_free_vgpr 256
  .amdhsa_next_free_sgpr 102
  .amdhsa_accum_offset 256
  .amdhsa_group_segment_fixed_size 0
  .amdhsa_kernarg_size 96
  .amdhsa_user_sgpr_count 2
  .amdhsa_user_sgpr_kernarg_segment_ptr 1
  .amdhsa_system_sgpr_workgroup_id_x 1
  .amdhsa_float_denorm_mode_32 3
.end_amdhsa_kernel
```
